```python
import torch

def _softmax(x, axis=-1):
    return torch.softmax(x, dim=axis)
def _gelu(x):
    return torch.nn.functional.gelu(x, approximate="tanh")
def _silu(x):
    return torch.nn.functional.silu(x)
def _sigmoid(x):
    return torch.sigmoid(x)
def _layernorm(x, axis=-1, eps=1e-5):
    m = x.mean(dim=axis, keepdim=True)
    v = x.var(dim=axis, keepdim=True, unbiased=False)
    return (x - m) / torch.sqrt(v + eps)
def _scatter_add(tgt, idx, src, axis=0):
    return tgt.clone().index_add_(axis, idx, src)
def _segment_sum(src, seg, n):
    out = torch.zeros((n,) + src.shape[1:], dtype=src.dtype)
    return out.index_add_(0, seg, src)
def _pad(x, pw):
    flat = tuple(v for pair in reversed(pw) for v in pair)
    return torch.nn.functional.pad(x, flat)

kernel_name = 'parallel_sum__gqa_block_cached__dense_activation_squared_relu__decode'

def setup_inputs():

    _w = (lambda a: (lambda t: t.to(torch.bfloat16) if t.is_floating_point() else t)(torch.as_tensor(a)))
    def _A_setup():
        B, Sq, D = 2, 1, 1024
        Hq, Hkv, Sk, Dh = 32, 4, 32768, 128
        assert Hq % Hkv == 0, (Hq, Hkv)
        return {
            "x": _w((lambda *s: torch.randn(*s, dtype=torch.bfloat16) * 0.05)(B, Sq, D)),
            "k_cache": _w((lambda *s: torch.randn(*s, dtype=torch.bfloat16) * 3.2)(B, Hkv, Sk, Dh)),
            "v_cache": _w((lambda *s: torch.randn(*s, dtype=torch.bfloat16) * 3.2)(B, Hkv, Sk, Dh)),
            "wq": _w((lambda *s: torch.randn(*s, dtype=torch.bfloat16) * 3.2)(D, Hq * Dh) * (D ** -0.5)),
            "wo": _w((lambda *s: torch.randn(*s, dtype=torch.bfloat16) * 3.2)(Hq * Dh, D) * ((Hq * Dh) ** -0.5)),
        }
    _A_in = _A_setup()

    def _B_setup():
        B, S, D, F = 2, 1, 1024, 3584
        return {
            "x": _w((lambda *s: torch.randn(*s, dtype=torch.bfloat16) * 0.05)(B, S, D)),
            "w1": _w((lambda *s: torch.randn(*s, dtype=torch.bfloat16) * 0.05)(D, F)),
            "b1": _w((lambda *s: torch.randn(*s, dtype=torch.bfloat16) * 0.8)(F)),
            "w2": _w((lambda *s: torch.randn(*s, dtype=torch.bfloat16) * 0.05)(F, D)),
            "b2": _w((lambda *s: torch.randn(*s, dtype=torch.bfloat16) * 6.4)(D)),
        }
    _B_in = _B_setup()

    return {
        "A_x": _A_in["x"],
        "A_k_cache": _A_in["k_cache"],
        "A_v_cache": _A_in["v_cache"],
        "A_wq": _A_in["wq"],
        "A_wo": _A_in["wo"],
        "B_x": _B_in["x"],
        "B_w1": _B_in["w1"],
        "B_b1": _B_in["b1"],
        "B_w2": _B_in["w2"],
        "B_b2": _B_in["b2"],
    }

def reference(A_x, A_k_cache, A_v_cache, A_wq, A_wo, B_x, B_w1, B_b1, B_w2, B_b2):
    def _A_ref(x, k_cache, v_cache, wq, wo):
        B, Sq, D = x.shape
        Hq, Dh = 32, 128
        Hkv = k_cache.shape[1]
        rep = Hq // Hkv
        q = (lambda x, *d: x.permute(*d))((x @ wq).reshape(B, Sq, Hq, Dh), 0, 2, 1, 3)
        k = (lambda x, n, axis: torch.repeat_interleave(x, n, dim=axis))(k_cache, rep, axis=1)
        v = (lambda x, n, axis: torch.repeat_interleave(x, n, dim=axis))(v_cache, rep, axis=1)
        scores = torch.einsum("bhqd,bhkd->bhqk", q, k) * (Dh ** -0.5)
        p = _softmax(scores, axis=-1)
        o = torch.einsum("bhqk,bhkd->bhqd", p, v)
        return (lambda x, *d: x.permute(*d))(o, 0, 2, 1, 3).reshape(B, Sq, Hq * Dh) @ wo

    def _B_ref(x, w1, b1, w2, b2):
        h = torch.einsum("bsd,df->bsf", x, w1) + b1
        zero = torch.zeros_like(h)
        r = torch.where(h > zero, h, zero)
        h = r * r
        out = torch.einsum("bsf,fd->bsd", h, w2) + b2
        return out

    x = A_x
    xn = _layernorm(x, axis=-1)
    return x + _A_ref(xn, A_k_cache, A_v_cache, A_wq, A_wo) + _B_ref(xn, B_w1, B_b1, B_w2, B_b2)
```

```asm
; @launch grid=(256,1,1) block=(512,1,1) lds=155648
.amdgcn_target "amdgcn-amd-amdhsa--gfx950"
.text
.globl parallel_sum__gqa_block_cached__dense_activation_squared_relu__decode_kernel
.p2align 8
.type parallel_sum__gqa_block_cached__dense_activation_squared_relu__decode_kernel,@function
parallel_sum__gqa_block_cached__dense_activation_squared_relu__decode_kernel:
    s_cmp_ge_u32 s2, 256
    s_cbranch_scc1 L_END
    s_load_dwordx16 s[4:19], s[0:1], 0
    s_load_dwordx8 s[20:27], s[0:1], 64
    s_load_dwordx2 s[28:29], s[0:1], 96
    v_lshrrev_b32 v1, 6, v0
    v_and_b32 v0, 63, v0
    v_readfirstlane_b32 s3, v1
    s_lshr_b32 s30, s2, 5
    s_and_b32 s31, s2, 31
    v_lshrrev_b32 v1, 4, v0
    v_and_b32 v2, 15, v0
    s_cmp_ge_u32 s3, 4
    s_cbranch_scc1 L_HELP
    v_mov_b32 v4, 0
    v_mov_b32 v5, 0
    v_mov_b32 v6, 0
    v_mov_b32 v7, 0
    v_mov_b32 v8, 21248
    ds_write_b128 v8, v[4:7]
    v_mov_b32 v5, 2
    ds_write_b32 v8, v5 offset:16
    s_lshl_b32 s36, s3, 8
    v_lshl_add_u32 v143, v0, 2, s36
    v_mov_b32 v142, 21248
    ds_write_b32 v143, v4 offset:21504
    ds_write_b32 v143, v4 offset:22528
    v_lshlrev_b32 v3, 1, v1
    v_xor_b32 v3, v3, v2
    v_lshlrev_b32 v3, 4, v3
    v_lshl_add_u32 v10, v1, 8, v3
    v_xor_b32 v11, 128, v10
    v_xor_b32 v12, 16, v10
    v_xor_b32 v13, 144, v10
    s_lshl_b32 s36, s30, 23
    s_lshl_b32 s37, s31, 2
    s_add_u32 s37, s37, s3
    s_lshl_b32 s37, s37, 12
    s_add_u32 s36, s36, s37
    s_mul_i32 s37, s30, 524288
    s_and_b32 s37, s37, 8388607
    s_mov_b32 s61, s37
    s_and_b32 s62, s31, 7
    s_lshl_b32 s62, s62, 14
    s_sub_u32 s62, s36, s62
    s_mov_b32 s63, 0x7fff
    s_mul_i32 s38, s3, 32768
    s_add_u32 s38, s38, 24576
    s_add_u32 s39, s38, 32768
    s_mov_b32 s40, s38
    s_mov_b32 s47, s38
    s_mov_b32 s49, 0
    s_mov_b32 s41, 0
    s_mov_b32 s34, 0x4000000
    s_mov_b32 s35, 0x20000
    s_waitcnt lgkmcnt(0)
    s_mov_b32 s32, s6
    s_mov_b32 s33, s7
    s_load_dword s59, s[28:29], 131072
    s_barrier
L_FILL:
    s_waitcnt vmcnt(4)
    s_mov_b32 m0, s47
    s_add_u32 s42, s36, s37
    buffer_load_dwordx4 v10, s[32:35], s42 offen nt lds
    buffer_load_dwordx4 v11, s[32:35], s42 offen offset:1024 nt lds
    buffer_load_dwordx4 v12, s[32:35], s42 offen offset:2048 nt lds
    buffer_load_dwordx4 v13, s[32:35], s42 offen offset:3072 nt lds
    s_add_u32 s37, s37, 524288
    s_and_b32 s37, s37, 8388607
    s_add_u32 s47, s47, 4096
    s_cmp_ge_u32 s47, s39
    s_cselect_b32 s47, s38, s47
    s_add_u32 s41, s41, 1
    s_cmp_lt_u32 s41, 7
    s_cbranch_scc1 L_FILL
    v_lshlrev_b32 v3, 1, v2
    v_and_b32 v3, 15, v3
    v_lshrrev_b32 v4, 3, v2
    v_or_b32 v3, v3, v4
    v_xor_b32 v3, v3, v1
    v_lshlrev_b32 v3, 4, v3
    v_lshl_add_u32 v14, v2, 8, v3
    v_lshrrev_b32 v3, 2, v2
    v_lshl_or_b32 v3, v1, 2, v3
    v_lshlrev_b32 v4, 1, v3
    v_and_b32 v4, 15, v4
    v_lshrrev_b32 v5, 3, v3
    v_or_b32 v4, v4, v5
    v_bfe_u32 v5, v2, 1, 1
    v_xor_b32 v4, v4, v5
    v_lshlrev_b32 v4, 4, v4
    v_lshl_add_u32 v15, v3, 8, v4
    v_and_b32 v5, 1, v2
    v_lshl_add_u32 v15, v5, 3, v15
    v_and_b32 v6, 7, v2
    v_lshl_add_u32 v3, v1, 3, v6
    s_lshl_b32 s43, s3, 12
    v_lshlrev_b32 v3, 3, v3
    v_add_u32 v16, s43, v3
    v_lshlrev_b32 v3, 4, v1
    v_lshl_add_u32 v17, v6, 8, v3
    v_mov_b32 v18, 0xff800000
    s_mov_b32 s44, 1035273459
    s_mov_b32 s45, 0xffff0000
    s_mov_b32 s46, 1069066811
    s_mov_b32 s57, 0xffffff00
    v_mov_b32 v19, 0
    v_lshrrev_b32 v3, 3, v0
    v_and_b32 v4, 7, v0
    v_lshrrev_b32 v5, 5, v0
    s_lshl_b32 s50, s30, 17
    s_lshl_b32 s51, s3, 15
    s_add_u32 s50, s50, s51
    s_lshl_b32 s51, s31, 7
    s_add_u32 s50, s50, s51
    s_add_u32 s50, s50, 1048576
    v_lshlrev_b32 v130, 12, v3
    v_lshl_add_u32 v130, v4, 4, v130
    v_add_u32 v130, s50, v130
    s_lshl_b32 s50, s30, 11
    s_lshl_b32 s51, s3, 9
    s_add_u32 s50, s50, s51
    s_and_b32 s51, s31, 7
    s_lshl_b32 s51, s51, 5
    s_add_u32 s50, s50, s51
    s_lshr_b32 s51, s31, 3
    s_lshl_b32 s51, s51, 3
    s_add_u32 s50, s50, s51
    s_add_u32 s50, s50, 2097152
    v_lshl_add_u32 v131, v5, 8, s50
    s_lshl_b32 s50, s3, 1
    v_add_u32 v7, s50, v5
    v_and_b32 v8, 31, v0
    v_xor_b32 v8, v8, v7
    v_lshlrev_b32 v8, 4, v8
    v_lshl_add_u32 v132, v7, 9, v8
    v_lshlrev_b32 v133, 3, v7
    s_lshr_b32 s50, s2, 1
    s_lshl_b32 s51, s50, 12
    s_add_u32 s51, s51, 1048576
    v_lshl_add_u32 v134, v0, 4, s51
    v_add_u32 v135, 0x80000, v134
    s_lshr_b32 s50, s50, 2
    s_lshl_b32 s50, s50, 8
    s_add_u32 s50, s50, 2097152
    v_lshl_add_u32 v136, v3, 5, s50
    v_add_u32 v137, 8192, v136
    v_lshlrev_b32 v7, 5, v4
    v_and_b32 v8, 16, v0
    v_add_u32 v7, v7, v8
    v_lshl_add_u32 v7, v5, 2, v7
    v_add_u32 v138, 20992, v7
    s_waitcnt lgkmcnt(0)
    s_add_u32 s59, s59, 1
    s_and_b32 s56, s59, 0xff
    s_and_b32 s58, s59, 0xffff
    v_mov_b32 v139, s56
    s_bitcmp1_b32 s2, 0
    s_cselect_b32 s60, 2, 2
    v_mov_b32 v140, 0
    v_mov_b32 v141, 1
    v_mov_b32 v142, 21248
    v_mov_b32 v96, 0
    v_mov_b32 v97, 0
    v_mov_b32 v98, 0
    v_mov_b32 v99, 0
    v_mov_b32 v100, 0
    v_mov_b32 v101, 0
    v_mov_b32 v102, 0
    v_mov_b32 v103, 0
    v_mov_b32 v104, 0
    v_mov_b32 v105, 0
    v_mov_b32 v106, 0
    v_mov_b32 v107, 0
    v_mov_b32 v108, 0
    v_mov_b32 v109, 0
    v_mov_b32 v110, 0
    v_mov_b32 v111, 0
    v_mov_b32 v112, 0
    v_mov_b32 v113, 0
    v_mov_b32 v114, 0
    v_mov_b32 v115, 0
    v_mov_b32 v116, 0
    v_mov_b32 v117, 0
    v_mov_b32 v118, 0
    v_mov_b32 v119, 0
    v_mov_b32 v120, 0
    v_mov_b32 v121, 0
    v_mov_b32 v122, 0
    v_mov_b32 v123, 0
    v_mov_b32 v124, 0
    v_mov_b32 v125, 0
    v_mov_b32 v126, 0
    v_mov_b32 v127, 0
    s_barrier
    ds_read_b128 v[20:23], v17 offset:16384
    ds_read_b128 v[24:27], v17 offset:16448
    ds_read_b128 v[28:31], v17 offset:16512
    ds_read_b128 v[32:35], v17 offset:16576
L_K:
    v_add_u32 v4, s40, v14
    v_xor_b32 v5, 64, v4
    v_xor_b32 v7, 128, v4
    v_xor_b32 v8, 192, v4
    s_cmp_lt_u32 s49, 7
    s_cbranch_scc1 L_K_CU
    s_sub_u32 s50, s41, s49
    s_cmp_ge_u32 s50, 3
    s_cbranch_scc1 L_K_A
    s_cmp_eq_u32 s50, 2
    s_cbranch_scc1 L_K_W2
    s_waitcnt vmcnt(0)
L_K_W2:
    s_waitcnt vmcnt(4)
L_K_BK:
    s_cmp_gt_u32 s50, s60
    s_cbranch_scc1 L_K_NI
L_K_ISSUE:
    s_mov_b32 m0, s47
    s_add_u32 s42, s36, s37
    buffer_load_dwordx4 v10, s[32:35], s42 offen nt lds
    buffer_load_dwordx4 v11, s[32:35], s42 offen offset:1024 nt lds
    buffer_load_dwordx4 v12, s[32:35], s42 offen offset:2048 nt lds
    buffer_load_dwordx4 v13, s[32:35], s42 offen offset:3072 nt lds
    s_add_u32 s37, s37, 524288
    s_and_b32 s37, s37, 8388607
    s_add_u32 s47, s47, 4096
    s_cmp_ge_u32 s47, s39
    s_cselect_b32 s47, s38, s47
    s_add_u32 s41, s41, 1
    s_cmp_eq_u32 s41, 14
    s_cselect_b32 s32, s8, s32
    s_cselect_b32 s33, s9, s33
    s_cselect_b32 s37, s61, s37
    s_cmp_ge_u32 s50, s60
    s_cbranch_scc1 L_K_NI
    s_mov_b32 m0, s47
    s_add_u32 s42, s36, s37
    buffer_load_dwordx4 v10, s[32:35], s42 offen nt lds
    buffer_load_dwordx4 v11, s[32:35], s42 offen offset:1024 nt lds
    buffer_load_dwordx4 v12, s[32:35], s42 offen offset:2048 nt lds
    buffer_load_dwordx4 v13, s[32:35], s42 offen offset:3072 nt lds
    s_add_u32 s37, s37, 524288
    s_and_b32 s37, s37, 8388607
    s_add_u32 s47, s47, 4096
    s_cmp_ge_u32 s47, s39
    s_cselect_b32 s47, s38, s47
    s_add_u32 s41, s41, 1
    s_cmp_eq_u32 s41, 14
    s_cselect_b32 s32, s8, s32
    s_cselect_b32 s33, s9, s33
    s_cselect_b32 s37, s61, s37
L_K_NI:
L_K_BODY:
    ds_read_b128 v[40:43], v4
    ds_read_b128 v[44:47], v5
    ds_read_b128 v[48:51], v7
    ds_read_b128 v[52:55], v8
    s_waitcnt lgkmcnt(0)
    v_mfma_f32_16x16x32_bf16 v[56:59], v[40:43], v[20:23], 0
    v_mfma_f32_16x16x32_bf16 v[56:59], v[44:47], v[24:27], v[56:59]
    v_mfma_f32_16x16x32_bf16 v[56:59], v[48:51], v[28:31], v[56:59]
    v_mfma_f32_16x16x32_bf16 v[56:59], v[52:55], v[32:35], v[56:59]
    s_add_u32 s40, s40, 4096
    s_cmp_ge_u32 s40, s39
    s_cselect_b32 s40, s38, s40
    s_add_u32 s49, s49, 1
    s_nop 3
    v_cvt_pk_bf16_f32 v60, v56, v57
    v_cvt_pk_bf16_f32 v61, v58, v59
    v_max3_f32 v18, v18, v56, v57
    v_max3_f32 v18, v18, v58, v59
    v_lshlrev_b32 v62, 16, v60
    v_and_b32 v63, s45, v60
    v_lshlrev_b32 v64, 16, v61
    v_and_b32 v65, s45, v61
    v_mul_f32 v62, s44, v62
    v_mul_f32 v63, s44, v63
    v_mul_f32 v64, s44, v64
    v_mul_f32 v65, s44, v65
    v_cvt_pk_bf16_f32 v60, v62, v63
    v_cvt_pk_bf16_f32 v61, v64, v65
    ds_write_b64 v16, v[60:61] offset:0
    v_add_u32 v16, 256, v16
    s_cmp_lt_u32 s49, 14
    s_cbranch_scc1 L_K
    v_mov_b32 v3, v18
    v_subrev_u32 v16, 3584, v16
    s_add_u32 s42, s36, s37
    s_lshl_b32 s50, s3, 8
    v_mov_b32 v146, s50
    s_nop 0
    v_permlane16_swap_b32 v18, v3
    v_max_f32 v18, v18, v3
    v_mov_b32 v3, v18
    s_nop 1
    v_permlane32_swap_b32 v18, v3
    v_max_f32 v18, v18, v3
    v_cvt_pk_bf16_f32 v18, v18, v18
    v_and_b32 v18, s45, v18
    v_mul_f32 v18, s44, v18
    v_cvt_pk_bf16_f32 v18, v18, v18
    v_and_b32 v18, s45, v18
L_V:
    v_add_u32 v40, s40, v15
    v_xor_b32 v41, 32, v40
    v_xor_b32 v42, 64, v40
    v_xor_b32 v43, 96, v40
    v_xor_b32 v44, 128, v40
    v_xor_b32 v45, 160, v40
    v_xor_b32 v46, 192, v40
    v_xor_b32 v47, 224, v40
    ds_read_b64 v[60:61], v16 offset:0
    v_mov_b32 v145, s49
    ds_write_b32 v143, v145 offset:21504
    v_add_u32 v16, 256, v16
    s_waitcnt lgkmcnt(0)
    v_lshlrev_b32 v62, 16, v60
    v_and_b32 v63, s45, v60
    v_lshlrev_b32 v64, 16, v61
    v_and_b32 v65, s45, v61
    v_sub_f32 v62, v62, v18
    v_sub_f32 v63, v63, v18
    v_sub_f32 v64, v64, v18
    v_sub_f32 v65, v65, v18
    v_mul_f32 v62, s46, v62
    v_mul_f32 v63, s46, v63
    v_mul_f32 v64, s46, v64
    v_mul_f32 v65, s46, v65
    v_exp_f32 v62, v62
    v_exp_f32 v63, v63
    v_exp_f32 v64, v64
    v_exp_f32 v65, v65
    s_waitcnt vmcnt(4)
    ds_read_b64_tr_b16 v[70:71], v40
    ds_read_b64_tr_b16 v[72:73], v41
    ds_read_b64_tr_b16 v[74:75], v42
    ds_read_b64_tr_b16 v[76:77], v43
    ds_read_b64_tr_b16 v[78:79], v44
    ds_read_b64_tr_b16 v[80:81], v45
    ds_read_b64_tr_b16 v[82:83], v46
    ds_read_b64_tr_b16 v[84:85], v47
    s_mov_b32 m0, s47
    s_nop 0
    buffer_load_dwordx4 v10, s[32:35], s42 offen offset:0 nt lds
    buffer_load_dwordx4 v11, s[32:35], s42 offen offset:1024 nt lds
    buffer_load_dwordx4 v12, s[32:35], s42 offen offset:2048 nt lds
    buffer_load_dwordx4 v13, s[32:35], s42 offen offset:3072 nt lds
    s_add_u32 s47, s47, 4096
    s_cmp_ge_u32 s47, s39
    s_cselect_b32 s47, s38, s47
    s_mov_b32 s32, s8
    s_mov_b32 s33, s9
    s_add_u32 s37, s37, 524288
    s_and_b32 s37, s37, 8388607
    s_add_u32 s50, s36, s37
    s_cmp_lt_u32 s49, 25
    s_cselect_b32 s42, s50, s42
L_V2:
    v_cvt_pk_bf16_f32 v66, v62, v63
    v_cvt_pk_bf16_f32 v67, v64, v65
    v_add_f32 v62, v62, v63
    v_add_f32 v64, v64, v65
    v_add_f32 v19, v19, v62
    v_add_f32 v19, v19, v64
    s_waitcnt lgkmcnt(0)
    v_mfma_f32_16x16x16_bf16 v[96:99], v[70:71], v[66:67], v[96:99]
    v_mfma_f32_16x16x16_bf16 v[100:103], v[72:73], v[66:67], v[100:103]
    v_mfma_f32_16x16x16_bf16 v[104:107], v[74:75], v[66:67], v[104:107]
    v_mfma_f32_16x16x16_bf16 v[108:111], v[76:77], v[66:67], v[108:111]
    v_mfma_f32_16x16x16_bf16 v[112:115], v[78:79], v[66:67], v[112:115]
    v_mfma_f32_16x16x16_bf16 v[116:119], v[80:81], v[66:67], v[116:119]
    v_mfma_f32_16x16x16_bf16 v[120:123], v[82:83], v[66:67], v[120:123]
    v_mfma_f32_16x16x16_bf16 v[124:127], v[84:85], v[66:67], v[124:127]
    s_add_u32 s40, s40, 4096
    s_cmp_ge_u32 s40, s39
    s_cselect_b32 s40, s38, s40
    s_add_u32 s49, s49, 1
    s_cmp_lt_u32 s49, 26
    s_cbranch_scc1 L_V
    s_cmp_eq_u32 s49, s63
    s_cbranch_scc1 L_VEND
    s_bitcmp1_b32 s49, 0
    s_cbranch_scc1 L_V
L_F:
    ds_read_b32 v144, v146 offset:22528
    s_waitcnt lgkmcnt(0)
    v_readfirstlane_b32 s50, v144
    s_cmp_eq_u32 s50, 0
    s_cbranch_scc1 L_F
    v_add_u32 v146, 4, v146
    s_sub_u32 s50, s50, 1
    s_lshr_b32 s51, s50, 3
    s_add_u32 s51, s51, 14
    s_lshl_b32 s51, s51, 19
    s_add_u32 s51, s51, s61
    s_and_b32 s51, s51, 8388607
    s_and_b32 s52, s50, 7
    s_lshl_b32 s52, s52, 14
    s_add_u32 s51, s51, s52
    s_add_u32 s51, s51, s62
    s_add_u32 s52, s49, 2
    s_mov_b32 s32, s6
    s_mov_b32 s33, s7
    s_cmp_ge_u32 s50, 16
    s_cselect_b32 s34, 0, s34
    s_cselect_b32 s63, s52, s63
    s_cselect_b32 s42, s42, s51
    s_cmp_eq_u32 s49, 26
    s_cbranch_scc1 L_V
    v_add_u32 v4, s40, v14
    v_xor_b32 v5, 64, v4
    v_xor_b32 v7, 128, v4
    v_xor_b32 v8, 192, v4
    v_mov_b32 v145, s49
    ds_write_b32 v143, v145 offset:21504
    v_subrev_u32 v16, 256, v16
    s_waitcnt vmcnt(4)
    ds_read_b128 v[40:43], v4
    ds_read_b128 v[44:47], v5
    ds_read_b128 v[48:51], v7
    ds_read_b128 v[52:55], v8
    s_mov_b32 m0, s47
    s_nop 0
    buffer_load_dwordx4 v10, s[32:35], s42 offen offset:0 nt lds
    buffer_load_dwordx4 v11, s[32:35], s42 offen offset:1024 nt lds
    buffer_load_dwordx4 v12, s[32:35], s42 offen offset:2048 nt lds
    buffer_load_dwordx4 v13, s[32:35], s42 offen offset:3072 nt lds
    s_add_u32 s47, s47, 4096
    s_cmp_ge_u32 s47, s39
    s_cselect_b32 s47, s38, s47
    s_mov_b32 s32, s8
    s_mov_b32 s33, s9
    s_waitcnt lgkmcnt(0)
    v_mfma_f32_16x16x32_bf16 v[56:59], v[40:43], v[20:23], 0
    v_mfma_f32_16x16x32_bf16 v[56:59], v[44:47], v[24:27], v[56:59]
    v_mfma_f32_16x16x32_bf16 v[56:59], v[48:51], v[28:31], v[56:59]
    v_mfma_f32_16x16x32_bf16 v[56:59], v[52:55], v[32:35], v[56:59]
    s_add_u32 s40, s40, 4096
    s_cmp_ge_u32 s40, s39
    s_cselect_b32 s40, s38, s40
    s_add_u32 s49, s49, 1
    s_nop 3
    v_cvt_pk_bf16_f32 v60, v56, v57
    v_cvt_pk_bf16_f32 v61, v58, v59
    v_lshlrev_b32 v62, 16, v60
    v_and_b32 v63, s45, v60
    v_lshlrev_b32 v64, 16, v61
    v_and_b32 v65, s45, v61
    v_mul_f32 v62, s44, v62
    v_mul_f32 v63, s44, v63
    v_mul_f32 v64, s44, v64
    v_mul_f32 v65, s44, v65
    v_cvt_pk_bf16_f32 v60, v62, v63
    v_cvt_pk_bf16_f32 v61, v64, v65
    ds_write_b64 v16, v[60:61] offset:0
    v_max3_f32 v62, v62, v63, v64
    v_max_f32 v62, v62, v65
    v_cvt_pk_bf16_f32 v62, v62, v62
    v_and_b32 v62, s45, v62
    v_max_f32 v62, v62, v18
    v_mov_b32 v3, v62
    s_nop 1
    v_permlane16_swap_b32 v62, v3
    v_max_f32 v62, v62, v3
    v_mov_b32 v3, v62
    s_nop 1
    v_permlane32_swap_b32 v62, v3
    v_max_f32 v62, v62, v3
    v_sub_f32 v64, v18, v62
    v_mov_b32 v18, v62
    v_mul_f32 v64, s46, v64
    v_exp_f32 v64, v64
    s_nop 0
    v_mul_f32 v19, v19, v64
    v_pk_mul_f32 v[96:97], v[96:97], v[64:65] op_sel_hi:[1,0]
    v_pk_mul_f32 v[98:99], v[98:99], v[64:65] op_sel_hi:[1,0]
    v_pk_mul_f32 v[100:101], v[100:101], v[64:65] op_sel_hi:[1,0]
    v_pk_mul_f32 v[102:103], v[102:103], v[64:65] op_sel_hi:[1,0]
    v_pk_mul_f32 v[104:105], v[104:105], v[64:65] op_sel_hi:[1,0]
    v_pk_mul_f32 v[106:107], v[106:107], v[64:65] op_sel_hi:[1,0]
    v_pk_mul_f32 v[108:109], v[108:109], v[64:65] op_sel_hi:[1,0]
    v_pk_mul_f32 v[110:111], v[110:111], v[64:65] op_sel_hi:[1,0]
    v_pk_mul_f32 v[112:113], v[112:113], v[64:65] op_sel_hi:[1,0]
    v_pk_mul_f32 v[114:115], v[114:115], v[64:65] op_sel_hi:[1,0]
    v_pk_mul_f32 v[116:117], v[116:117], v[64:65] op_sel_hi:[1,0]
    v_pk_mul_f32 v[118:119], v[118:119], v[64:65] op_sel_hi:[1,0]
    v_pk_mul_f32 v[120:121], v[120:121], v[64:65] op_sel_hi:[1,0]
    v_pk_mul_f32 v[122:123], v[122:123], v[64:65] op_sel_hi:[1,0]
    v_pk_mul_f32 v[124:125], v[124:125], v[64:65] op_sel_hi:[1,0]
    v_pk_mul_f32 v[126:127], v[126:127], v[64:65] op_sel_hi:[1,0]
    s_branch L_V
L_VEND:
    s_setprio 3
    v_mov_b32 v3, v19
    v_xor_b32 v4, v1, v6
    v_lshlrev_b32 v4, 4, v4
    v_permlane16_swap_b32 v19, v3
    v_add_f32 v19, v19, v3
    v_mov_b32 v3, v19
    v_lshl_add_u32 v4, v6, 9, v4
    v_add_u32 v40, s43, v4
    v_permlane32_swap_b32 v19, v3
    v_add_f32 v19, v19, v3
    s_lshl_b32 s47, s3, 6
    v_lshlrev_b32 v5, 3, v6
    v_add_u32 v5, s47, v5
    v_xor_b32 v41, 64, v40
    v_xor_b32 v42, 128, v40
    v_xor_b32 v43, 192, v40
    v_xor_b32 v44, 256, v40
    v_xor_b32 v45, 320, v40
    v_xor_b32 v46, 384, v40
    v_xor_b32 v47, 448, v40
    ds_write_b128 v40, v[96:99] offset:0
    ds_write_b128 v41, v[100:103] offset:0
    ds_write_b128 v42, v[104:107] offset:0
    ds_write_b128 v43, v[108:111] offset:0
    ds_write_b128 v44, v[112:115] offset:0
    ds_write_b128 v45, v[116:119] offset:0
    ds_write_b128 v46, v[120:123] offset:0
    ds_write_b128 v47, v[124:127] offset:0
    ds_write_b64 v5, v[18:19] offset:20480
    s_waitcnt lgkmcnt(0)
    s_mov_b64 exec, 1
    ds_add_u32 v142, v141 offset:4
    s_mov_b64 exec, -1
L_ENDW:
    ds_read_b32 v3, v142 offset:4
    s_waitcnt lgkmcnt(0)
    v_readfirstlane_b32 s50, v3
    s_cmp_lt_u32 s50, 4
    s_cbranch_scc1 L_ENDW
    ds_read_b64 v[16:17], v133 offset:20480
    ds_read_b64 v[18:19], v133 offset:20544
    ds_read_b64 v[20:21], v133 offset:20608
    ds_read_b64 v[22:23], v133 offset:20672
    ds_read_b128 v[32:35], v132 offset:0
    ds_read_b128 v[36:39], v132 offset:4096
    ds_read_b128 v[40:43], v132 offset:8192
    ds_read_b128 v[44:47], v132 offset:12288
    s_waitcnt lgkmcnt(4)
    v_max3_f32 v24, v16, v18, v20
    v_max_f32 v24, v24, v22
    v_sub_f32 v16, v16, v24
    v_sub_f32 v18, v18, v24
    v_sub_f32 v20, v20, v24
    v_sub_f32 v22, v22, v24
    v_mul_f32 v16, s46, v16
    v_mul_f32 v18, s46, v18
    v_mul_f32 v20, s46, v20
    v_mul_f32 v22, s46, v22
    v_exp_f32 v16, v16
    v_exp_f32 v18, v18
    v_exp_f32 v20, v20
    v_exp_f32 v22, v22
    s_waitcnt lgkmcnt(0)
    v_pk_mul_f32 v[32:33], v[32:33], v[16:17] op_sel_hi:[1,0]
    v_pk_mul_f32 v[34:35], v[34:35], v[16:17] op_sel_hi:[1,0]
    v_pk_fma_f32 v[32:33], v[36:37], v[18:19], v[32:33] op_sel_hi:[1,0,1]
    v_pk_fma_f32 v[34:35], v[38:39], v[18:19], v[34:35] op_sel_hi:[1,0,1]
    v_pk_fma_f32 v[32:33], v[40:41], v[20:21], v[32:33] op_sel_hi:[1,0,1]
    v_pk_fma_f32 v[34:35], v[42:43], v[20:21], v[34:35] op_sel_hi:[1,0,1]
    v_pk_fma_f32 v[32:33], v[44:45], v[22:23], v[32:33] op_sel_hi:[1,0,1]
    v_pk_fma_f32 v[34:35], v[46:47], v[22:23], v[34:35] op_sel_hi:[1,0,1]
    v_and_or_b32 v32, v32, s57, v139
    v_and_or_b32 v33, v33, s57, v139
    v_and_or_b32 v34, v34, s57, v139
    v_and_or_b32 v35, v35, s57, v139
    global_store_dwordx4 v130, v[32:35], s[28:29] sc1
    v_mul_f32 v25, v16, v17
    v_fma_f32 v25, v18, v19, v25
    v_fma_f32 v25, v20, v21, v25
    v_fma_f32 v25, v22, v23, v25
    v_or_b32 v24, s58, v24
    v_and_or_b32 v25, v25, s57, v139
    s_mov_b32 exec_lo, 1
    s_mov_b32 exec_hi, 1
    global_store_dwordx2 v131, v[24:25], s[28:29] sc1
    s_mov_b64 exec, -1
    s_cmp_lg_u32 s3, 0
    s_cbranch_scc1 L_SEND
    s_mov_b32 s49, 40000
L_POLL1:
    global_load_dwordx4 v[16:19], v136, s[28:29] sc1
    global_load_dwordx4 v[20:23], v136, s[28:29] offset:16 sc1
    global_load_dwordx4 v[24:27], v137, s[28:29] sc1
    global_load_dwordx4 v[28:31], v137, s[28:29] offset:16 sc1
    global_load_dwordx4 v[64:67], v134, s[28:29] offset:0 sc1
    global_load_dwordx4 v[68:71], v134, s[28:29] offset:1024 sc1
    global_load_dwordx4 v[72:75], v134, s[28:29] offset:2048 sc1
    global_load_dwordx4 v[76:79], v134, s[28:29] offset:3072 sc1
    global_load_dwordx4 v[80:83], v135, s[28:29] offset:0 sc1
    global_load_dwordx4 v[84:87], v135, s[28:29] offset:1024 sc1
    global_load_dwordx4 v[88:91], v135, s[28:29] offset:2048 sc1
    global_load_dwordx4 v[92:95], v135, s[28:29] offset:3072 sc1
    s_waitcnt vmcnt(8)
    v_xor_b32 v16, s58, v16
    v_xor_b32 v18, s58, v18
    v_xor_b32 v20, s58, v20
    v_xor_b32 v22, s58, v22
    v_xor_b32 v24, s58, v24
    v_xor_b32 v26, s58, v26
    v_xor_b32 v28, s58, v28
    v_xor_b32 v30, s58, v30
    v_xor_b32 v17, s56, v17
    v_xor_b32 v19, s56, v19
    v_xor_b32 v21, s56, v21
    v_xor_b32 v23, s56, v23
    v_xor_b32 v25, s56, v25
    v_xor_b32 v27, s56, v27
    v_xor_b32 v29, s56, v29
    v_xor_b32 v31, s56, v31
    v_or3_b32 v60, v16, v18, v20
    v_or3_b32 v60, v60, v22, v24
    v_or3_b32 v60, v60, v26, v28
    v_or_b32 v60, v60, v30
    v_and_b32 v60, 0xffff, v60
    v_or3_b32 v40, v17, v19, v21
    v_or3_b32 v40, v40, v23, v25
    v_or3_b32 v40, v40, v27, v29
    v_or_b32 v40, v40, v31
    s_waitcnt vmcnt(4)
    v_xor_b32 v64, s56, v64
    v_xor_b32 v65, s56, v65
    v_xor_b32 v66, s56, v66
    v_xor_b32 v67, s56, v67
    v_xor_b32 v68, s56, v68
    v_xor_b32 v69, s56, v69
    v_xor_b32 v70, s56, v70
    v_xor_b32 v71, s56, v71
    v_xor_b32 v72, s56, v72
    v_xor_b32 v73, s56, v73
    v_xor_b32 v74, s56, v74
    v_xor_b32 v75, s56, v75
    v_xor_b32 v76, s56, v76
    v_xor_b32 v77, s56, v77
    v_xor_b32 v78, s56, v78
    v_xor_b32 v79, s56, v79
    s_waitcnt vmcnt(0)
    v_xor_b32 v80, s56, v80
    v_xor_b32 v81, s56, v81
    v_xor_b32 v82, s56, v82
    v_xor_b32 v83, s56, v83
    v_xor_b32 v84, s56, v84
    v_xor_b32 v85, s56, v85
    v_xor_b32 v86, s56, v86
    v_xor_b32 v87, s56, v87
    v_xor_b32 v88, s56, v88
    v_xor_b32 v89, s56, v89
    v_xor_b32 v90, s56, v90
    v_xor_b32 v91, s56, v91
    v_xor_b32 v92, s56, v92
    v_xor_b32 v93, s56, v93
    v_xor_b32 v94, s56, v94
    v_xor_b32 v95, s56, v95
    v_or3_b32 v40, v40, v64, v65
    v_or3_b32 v40, v40, v66, v67
    v_or3_b32 v40, v40, v68, v69
    v_or3_b32 v40, v40, v70, v71
    v_or3_b32 v40, v40, v72, v73
    v_or3_b32 v40, v40, v74, v75
    v_or3_b32 v40, v40, v76, v77
    v_or3_b32 v40, v40, v78, v79
    v_or3_b32 v40, v40, v80, v81
    v_or3_b32 v40, v40, v82, v83
    v_or3_b32 v40, v40, v84, v85
    v_or3_b32 v40, v40, v86, v87
    v_or3_b32 v40, v40, v88, v89
    v_or3_b32 v40, v40, v90, v91
    v_or3_b32 v40, v40, v92, v93
    v_or3_b32 v40, v40, v94, v95
    v_and_b32 v40, 0xff, v40
    v_or_b32 v40, v40, v60
    v_cmp_ne_u32 vcc, 0, v40
    s_cbranch_vccz L_POLL1_OK
    s_mov_b64 exec, vcc
    s_sub_u32 s49, s49, 1
    s_cbranch_scc0 L_POLL1
L_POLL1_OK:
    s_mov_b64 exec, -1
    v_max3_f32 v32, v16, v18, v20
    v_max3_f32 v33, v24, v26, v28
    v_max_f32 v32, v32, v22
    v_max_f32 v33, v33, v30
    s_nop 1
    v_permlane32_swap_b32 v32, v33
    v_max_f32 v32, v32, v33
    v_mov_b32 v33, v32
    s_nop 1
    v_permlane16_swap_b32 v32, v33
    v_max_f32 v32, v32, v33
    s_nop 1
    v_max_f32_dpp v32, v32, v32 row_ror:8 row_mask:0xf bank_mask:0xf
    s_nop 0
    v_readlane_b32 s38, v32, 0
    v_readlane_b32 s39, v32, 32
    s_nop 0
    v_subrev_f32 v16, s38, v16
    v_subrev_f32 v18, s38, v18
    v_subrev_f32 v20, s38, v20
    v_subrev_f32 v22, s38, v22
    v_subrev_f32 v24, s39, v24
    v_subrev_f32 v26, s39, v26
    v_subrev_f32 v28, s39, v28
    v_subrev_f32 v30, s39, v30
    v_mul_f32 v16, s46, v16
    v_mul_f32 v18, s46, v18
    v_mul_f32 v20, s46, v20
    v_mul_f32 v22, s46, v22
    v_mul_f32 v24, s46, v24
    v_mul_f32 v26, s46, v26
    v_mul_f32 v28, s46, v28
    v_mul_f32 v30, s46, v30
    v_exp_f32 v16, v16
    v_exp_f32 v18, v18
    v_exp_f32 v20, v20
    v_exp_f32 v22, v22
    v_exp_f32 v24, v24
    v_exp_f32 v26, v26
    v_exp_f32 v28, v28
    v_exp_f32 v30, v30
    v_mul_f32 v40, v16, v17
    v_pk_mul_f32 v[32:33], v[64:65], v[16:17] op_sel_hi:[1,0]
    v_pk_mul_f32 v[34:35], v[66:67], v[16:17] op_sel_hi:[1,0]
    v_fma_f32 v40, v18, v19, v40
    v_pk_fma_f32 v[32:33], v[68:69], v[18:19], v[32:33] op_sel_hi:[1,0,1]
    v_pk_fma_f32 v[34:35], v[70:71], v[18:19], v[34:35] op_sel_hi:[1,0,1]
    v_fma_f32 v40, v20, v21, v40
    v_pk_fma_f32 v[32:33], v[72:73], v[20:21], v[32:33] op_sel_hi:[1,0,1]
    v_pk_fma_f32 v[34:35], v[74:75], v[20:21], v[34:35] op_sel_hi:[1,0,1]
    v_fma_f32 v40, v22, v23, v40
    v_pk_fma_f32 v[32:33], v[76:77], v[22:23], v[32:33] op_sel_hi:[1,0,1]
    v_pk_fma_f32 v[34:35], v[78:79], v[22:23], v[34:35] op_sel_hi:[1,0,1]
    v_mul_f32 v41, v24, v25
    v_pk_mul_f32 v[36:37], v[80:81], v[24:25] op_sel_hi:[1,0]
    v_pk_mul_f32 v[38:39], v[82:83], v[24:25] op_sel_hi:[1,0]
    v_fma_f32 v41, v26, v27, v41
    v_pk_fma_f32 v[36:37], v[84:85], v[26:27], v[36:37] op_sel_hi:[1,0,1]
    v_pk_fma_f32 v[38:39], v[86:87], v[26:27], v[38:39] op_sel_hi:[1,0,1]
    v_fma_f32 v41, v28, v29, v41
    v_pk_fma_f32 v[36:37], v[88:89], v[28:29], v[36:37] op_sel_hi:[1,0,1]
    v_pk_fma_f32 v[38:39], v[90:91], v[28:29], v[38:39] op_sel_hi:[1,0,1]
    v_fma_f32 v41, v30, v31, v41
    v_pk_fma_f32 v[36:37], v[92:93], v[30:31], v[36:37] op_sel_hi:[1,0,1]
    v_pk_fma_f32 v[38:39], v[94:95], v[30:31], v[38:39] op_sel_hi:[1,0,1]
    s_nop 0
    v_permlane32_swap_b32 v40, v41
    v_permlane32_swap_b32 v32, v36
    v_permlane32_swap_b32 v33, v37
    v_permlane32_swap_b32 v34, v38
    v_permlane32_swap_b32 v35, v39
    v_add_f32 v40, v40, v41
    v_add_f32 v32, v32, v36
    v_add_f32 v33, v33, v37
    v_add_f32 v34, v34, v38
    v_add_f32 v35, v35, v39
    v_mov_b32 v41, v40
    s_nop 0
    v_permlane16_swap_b32 v32, v34
    v_permlane16_swap_b32 v33, v35
    v_permlane16_swap_b32 v40, v41
    v_add_f32 v32, v32, v34
    v_add_f32 v33, v33, v35
    v_add_f32 v40, v40, v41
    v_add_f32_dpp v32, v32, v32 row_ror:8 row_mask:0xf bank_mask:0xf
    v_add_f32_dpp v33, v33, v33 row_ror:8 row_mask:0xf bank_mask:0xf
    v_add_f32_dpp v40, v40, v40 row_ror:8 row_mask:0xf bank_mask:0xf
    v_rcp_f32 v40, v40
    s_nop 0
    v_mul_f32 v32, v32, v40
    v_mul_f32 v33, v33, v40
    v_cvt_pk_bf16_f32 v32, v32, v33
    v_and_b32 v33, s45, v32
    v_lshlrev_b32 v32, 16, v32
    ds_write2_b32 v138, v32, v33 offset0:0 offset1:2
    s_waitcnt lgkmcnt(0)
    s_barrier
L_SEND:
    s_waitcnt vmcnt(0)
    s_endpgm
L_K_CU:
    s_mov_b32 s50, 15
    s_waitcnt vmcnt(8)
    s_cmp_lt_u32 s49, 2
    s_cbranch_scc1 L_K_ISSUE
    s_branch L_K_BODY
L_K_A:
    s_cmp_ge_u32 s50, 5
    s_cbranch_scc1 L_K_W5
    s_cmp_eq_u32 s50, 4
    s_cbranch_scc1 L_K_W4
    s_waitcnt vmcnt(8)
L_K_W4:
    s_waitcnt vmcnt(12)
L_K_W5:
    s_waitcnt vmcnt(16)
    s_branch L_K_BK
L_HELP:
    s_setprio 3
    s_sub_u32 s3, s3, 4
    s_and_b32 s32, s2, 63
    s_lshr_b32 s33, s2, 6
    v_lshrrev_b32 v3, 3, v0
    v_and_b32 v4, 7, v0
    s_lshl_b32 s36, s3, 6
    v_lshl_add_u32 v5, v3, 3, s36
    s_lshl_b32 s37, s33, 8
    v_add_u32 v6, s37, v5
    v_lshlrev_b32 v8, 5, v0
    v_lshlrev_b32 v9, 1, v6
    v_lshlrev_b32 v11, 13, v6
    v_lshl_add_u32 v11, v4, 4, v11
    s_lshl_b32 s37, s32, 7
    v_add_u32 v11, s37, v11
    s_mov_b32 s42, 8192
    s_waitcnt lgkmcnt(0)
    s_load_dword s59, s[28:29], 131072
    global_load_dwordx4 v[176:179], v8, s[4:5]
    global_load_dwordx4 v[180:183], v8, s[4:5] offset:16
    global_load_dwordx4 v[184:187], v8, s[4:5] offset:2048
    global_load_dwordx4 v[188:191], v8, s[4:5] offset:2064
    global_load_dwordx4 v[160:163], v9, s[4:5]
    global_load_dwordx4 v[164:167], v9, s[4:5] offset:2048
    global_load_dwordx4 v[64:67], v11, s[10:11] nt
    v_add_u32 v11, s42, v11
    global_load_dwordx4 v[68:71], v11, s[10:11] nt
    v_add_u32 v11, s42, v11
    global_load_dwordx4 v[72:75], v11, s[10:11] nt
    v_add_u32 v11, s42, v11
    global_load_dwordx4 v[76:79], v11, s[10:11] nt
    v_add_u32 v11, s42, v11
    global_load_dwordx4 v[80:83], v11, s[10:11] nt
    v_add_u32 v11, s42, v11
    global_load_dwordx4 v[84:87], v11, s[10:11] nt
    v_add_u32 v11, s42, v11
    global_load_dwordx4 v[88:91], v11, s[10:11] nt
    v_add_u32 v11, s42, v11
    global_load_dwordx4 v[92:95], v11, s[10:11] nt
    s_lshl_b32 s39, s3, 1
    s_add_u32 s38, s33, s39
    s_cmp_ge_u32 s38, 2
    s_cbranch_scc1 L_NOCI
    s_lshl_b32 s38, s2, 8
    s_add_u32 s38, s38, 393216
    v_mov_b32 v12, s38
    v_mov_b32 v13, 0
    s_mov_b64 exec, 1
    global_store_dword v12, v13, s[28:29] sc1
    s_mov_b64 exec, -1
L_NOCI:
    s_barrier
    s_cmp_ge_u32 s2, 224
    s_cselect_b32 s34, 224, 0
    s_sub_u32 s34, s2, s34
    s_lshr_b32 s43, s34, 1
    s_mul_i32 s35, s34, 1171
    s_lshr_b32 s35, s35, 16
    s_mul_i32 s36, s35, 56
    s_sub_u32 s34, s34, s36
    s_lshl_b32 s37, s35, 8
    v_add_u32 v7, s37, v5
    v_lshlrev_b32 v10, 1, v7
    v_mul_u32_u24 v11, 7168, v7
    v_lshl_add_u32 v11, v4, 4, v11
    s_lshl_b32 s37, s34, 7
    v_add_u32 v11, s37, v11
    s_mov_b32 s42, 7168
    global_load_dwordx4 v[168:171], v10, s[4:5]
    global_load_dwordx4 v[172:175], v10, s[4:5] offset:2048
    s_mov_b32 s45, 0xffff0000
    s_mov_b32 s57, 0xffffff00
    s_mov_b32 s48, 0
    v_and_b32 v57, 1, v0
    v_lshl_add_u32 v57, v57, 2, v1
    s_and_b32 s38, s2, 127
    s_lshl_b32 s38, s38, 3
    v_add_u32 v57, s38, v57
    v_lshlrev_b32 v57, 1, v57
    v_bfe_u32 v58, v0, 1, 1
    v_lshl_add_u32 v8, v58, 11, v57
    global_load_ushort v7, v57, s[22:23]
    global_load_ushort v6, v8, s[4:5]
    s_lshl_b32 s38, s43, 5
    v_lshl_add_u32 v57, v4, 2, v1
    v_add_u32 v58, s38, v57
    v_lshlrev_b32 v58, 1, v58
    global_load_ushort v5, v58, s[18:19]
    v_and_b32 v58, 1, v3
    v_lshlrev_b32 v58, 2, v58
    v_lshl_add_u32 v62, v57, 3, v58
    s_lshr_b32 s36, s30, 2
    s_and_b32 s37, s30, 3
    v_lshrrev_b32 v58, 5, v0
    s_and_b32 s38, s2, 1
    s_lshl_b32 s38, s38, 19
    s_lshl_b32 s39, s3, 17
    s_add_u32 s38, s38, s39
    s_lshr_b32 s39, s2, 1
    s_lshl_b32 s39, s39, 6
    s_add_u32 s38, s38, s39
    s_add_u32 s38, s38, 3145728
    v_lshlrev_b32 v14, 13, v2
    v_lshl_add_u32 v14, v1, 4, v14
    v_add_u32 v14, s38, v14
    s_lshl_b32 s38, s34, 13
    s_lshl_b32 s39, s35, 10
    s_add_u32 s38, s38, s39
    s_lshl_b32 s39, s3, 8
    s_add_u32 s38, s38, s39
    s_add_u32 s38, s38, 524288
    v_lshrrev_b32 v15, 2, v4
    v_lshlrev_b32 v15, 12, v15
    v_lshl_add_u32 v15, v58, 7, v15
    v_and_b32 v57, 3, v0
    v_lshl_add_u32 v15, v57, 5, v15
    v_and_b32 v57, 16, v0
    v_add3_u32 v15, v15, v57, s38
    v_lshlrev_b32 v13, 8, v58
    v_lshl_add_u32 v13, v4, 5, v13
    s_lshl_b32 s38, s3, 9
    v_add3_u32 v13, v13, v57, s38
    s_and_b32 s39, s2, 1
    s_lshl_b32 s39, s39, 10
    s_lshl_b32 s38, s3, 8
    s_add_u32 s38, s38, s39
    s_add_u32 s38, s38, 4096
    v_lshlrev_b32 v9, 14, v1
    v_lshl_add_u32 v9, v2, 4, v9
    v_add_u32 v9, s38, v9
    s_lshl_b32 s38, s36, 14
    s_lshl_b32 s39, s37, 12
    s_add_u32 s38, s38, s39
    s_lshl_b32 s39, s3, 10
    s_add_u32 s38, s38, s39
    v_lshl_add_u32 v10, v0, 4, s38
    v_add_u32 v12, 0x8000, v10
    v_add_u32 v56, 0x10000, v10
    v_add_u32 v59, 0x18000, v10
    v_mov_b32 v63, 21248
    s_waitcnt vmcnt(13) lgkmcnt(0)
    s_add_u32 s59, s59, 1
    s_and_b32 s56, s59, 0xff
    v_mov_b32 v61, s56
    v_lshlrev_b32 v96, 16, v176
    v_and_b32 v97, s45, v176
    v_lshlrev_b32 v98, 16, v177
    v_and_b32 v99, s45, v177
    v_lshlrev_b32 v100, 16, v178
    v_and_b32 v101, s45, v178
    v_lshlrev_b32 v102, 16, v179
    v_and_b32 v103, s45, v179
    v_lshlrev_b32 v104, 16, v180
    v_and_b32 v105, s45, v180
    v_lshlrev_b32 v106, 16, v181
    v_and_b32 v107, s45, v181
    v_lshlrev_b32 v108, 16, v182
    v_and_b32 v109, s45, v182
    v_lshlrev_b32 v110, 16, v183
    v_and_b32 v111, s45, v183
    v_lshlrev_b32 v112, 16, v184
    v_and_b32 v113, s45, v184
    v_lshlrev_b32 v114, 16, v185
    v_and_b32 v115, s45, v185
    v_lshlrev_b32 v116, 16, v186
    v_and_b32 v117, s45, v186
    v_lshlrev_b32 v118, 16, v187
    v_and_b32 v119, s45, v187
    v_lshlrev_b32 v120, 16, v188
    v_and_b32 v121, s45, v188
    v_lshlrev_b32 v122, 16, v189
    v_and_b32 v123, s45, v189
    v_lshlrev_b32 v124, 16, v190
    v_and_b32 v125, s45, v190
    v_lshlrev_b32 v126, 16, v191
    v_and_b32 v127, s45, v191
    v_pk_add_f32 v[48:49], v[96:97], v[98:99]
    v_pk_add_f32 v[50:51], v[112:113], v[114:115]
    v_pk_add_f32 v[48:49], v[48:49], v[100:101]
    v_pk_add_f32 v[50:51], v[50:51], v[116:117]
    v_pk_add_f32 v[48:49], v[48:49], v[102:103]
    v_pk_add_f32 v[50:51], v[50:51], v[118:119]
    v_pk_add_f32 v[48:49], v[48:49], v[104:105]
    v_pk_add_f32 v[50:51], v[50:51], v[120:121]
    v_pk_add_f32 v[48:49], v[48:49], v[106:107]
    v_pk_add_f32 v[50:51], v[50:51], v[122:123]
    v_pk_add_f32 v[48:49], v[48:49], v[108:109]
    v_pk_add_f32 v[50:51], v[50:51], v[124:125]
    v_pk_add_f32 v[48:49], v[48:49], v[110:111]
    v_pk_add_f32 v[50:51], v[50:51], v[126:127]
    v_add_f32 v48, v48, v49
    v_add_f32 v50, v50, v51
    s_nop 1
    v_permlane32_swap_b32 v48, v50
    v_add_f32 v48, v48, v50
    v_mov_b32 v49, v48
    s_nop 1
    v_permlane16_swap_b32 v48, v49
    v_add_f32 v48, v48, v49
    s_nop 1
    v_add_f32_dpp v48, v48, v48 row_ror:8 row_mask:0xf bank_mask:0xf
    s_nop 1
    v_add_f32_dpp v48, v48, v48 row_ror:4 row_mask:0xf bank_mask:0xf
    s_nop 1
    v_add_f32_dpp v48, v48, v48 row_ror:2 row_mask:0xf bank_mask:0xf
    s_nop 1
    v_add_f32_dpp v48, v48, v48 row_ror:1 row_mask:0xf bank_mask:0xf
    v_mul_f32 v48, 981467136, v48
    s_nop 0
    v_readlane_b32 s50, v48, 0
    v_readlane_b32 s52, v48, 32
    s_mov_b32 s51, s50
    s_mov_b32 s53, s52
    v_pk_add_f32 v[96:97], v[96:97], s[50:51] neg_lo:[0,1] neg_hi:[0,1]
    v_pk_add_f32 v[112:113], v[112:113], s[52:53] neg_lo:[0,1] neg_hi:[0,1]
    v_pk_add_f32 v[98:99], v[98:99], s[50:51] neg_lo:[0,1] neg_hi:[0,1]
    v_pk_add_f32 v[114:115], v[114:115], s[52:53] neg_lo:[0,1] neg_hi:[0,1]
    v_pk_add_f32 v[100:101], v[100:101], s[50:51] neg_lo:[0,1] neg_hi:[0,1]
    v_pk_add_f32 v[116:117], v[116:117], s[52:53] neg_lo:[0,1] neg_hi:[0,1]
    v_pk_add_f32 v[102:103], v[102:103], s[50:51] neg_lo:[0,1] neg_hi:[0,1]
    v_pk_add_f32 v[118:119], v[118:119], s[52:53] neg_lo:[0,1] neg_hi:[0,1]
    v_pk_add_f32 v[104:105], v[104:105], s[50:51] neg_lo:[0,1] neg_hi:[0,1]
    v_pk_add_f32 v[120:121], v[120:121], s[52:53] neg_lo:[0,1] neg_hi:[0,1]
    v_pk_add_f32 v[106:107], v[106:107], s[50:51] neg_lo:[0,1] neg_hi:[0,1]
    v_pk_add_f32 v[122:123], v[122:123], s[52:53] neg_lo:[0,1] neg_hi:[0,1]
    v_pk_add_f32 v[108:109], v[108:109], s[50:51] neg_lo:[0,1] neg_hi:[0,1]
    v_pk_add_f32 v[124:125], v[124:125], s[52:53] neg_lo:[0,1] neg_hi:[0,1]
    v_pk_add_f32 v[110:111], v[110:111], s[50:51] neg_lo:[0,1] neg_hi:[0,1]
    v_pk_add_f32 v[126:127], v[126:127], s[52:53] neg_lo:[0,1] neg_hi:[0,1]
    v_pk_mul_f32 v[50:51], v[96:97], v[96:97]
    v_pk_mul_f32 v[52:53], v[112:113], v[112:113]
    v_pk_fma_f32 v[50:51], v[98:99], v[98:99], v[50:51]
    v_pk_fma_f32 v[52:53], v[114:115], v[114:115], v[52:53]
    v_pk_fma_f32 v[50:51], v[100:101], v[100:101], v[50:51]
    v_pk_fma_f32 v[52:53], v[116:117], v[116:117], v[52:53]
    v_pk_fma_f32 v[50:51], v[102:103], v[102:103], v[50:51]
    v_pk_fma_f32 v[52:53], v[118:119], v[118:119], v[52:53]
    v_pk_fma_f32 v[50:51], v[104:105], v[104:105], v[50:51]
    v_pk_fma_f32 v[52:53], v[120:121], v[120:121], v[52:53]
    v_pk_fma_f32 v[50:51], v[106:107], v[106:107], v[50:51]
    v_pk_fma_f32 v[52:53], v[122:123], v[122:123], v[52:53]
    v_pk_fma_f32 v[50:51], v[108:109], v[108:109], v[50:51]
    v_pk_fma_f32 v[52:53], v[124:125], v[124:125], v[52:53]
    v_pk_fma_f32 v[50:51], v[110:111], v[110:111], v[50:51]
    v_pk_fma_f32 v[52:53], v[126:127], v[126:127], v[52:53]
    v_add_f32 v50, v50, v51
    v_add_f32 v52, v52, v53
    s_nop 1
    v_permlane32_swap_b32 v50, v52
    v_add_f32 v50, v50, v52
    v_mov_b32 v51, v50
    s_nop 1
    v_permlane16_swap_b32 v50, v51
    v_add_f32 v50, v50, v51
    s_nop 1
    v_add_f32_dpp v50, v50, v50 row_ror:8 row_mask:0xf bank_mask:0xf
    s_nop 1
    v_add_f32_dpp v50, v50, v50 row_ror:4 row_mask:0xf bank_mask:0xf
    s_nop 1
    v_add_f32_dpp v50, v50, v50 row_ror:2 row_mask:0xf bank_mask:0xf
    s_nop 1
    v_add_f32_dpp v50, v50, v50 row_ror:1 row_mask:0xf bank_mask:0xf
    v_mul_f32 v50, 981467136, v50
    v_cvt_pk_bf16_f32 v50, v50, v48
    v_and_b32 v48, s45, v50
    v_lshlrev_b32 v50, 16, v50
    v_add_f32 v50, 925353388, v50
    v_cvt_pk_bf16_f32 v50, v50, v50
    v_and_b32 v50, s45, v50
    v_sqrt_f32 v51, v50
    s_nop 0
    v_cvt_pk_bf16_f32 v51, v51, v51
    v_and_b32 v51, s45, v51
    v_rcp_f32 v52, v51
    v_readlane_b32 s50, v48, 0
    v_readlane_b32 s51, v48, 32
    v_readlane_b32 s52, v51, 0
    v_readlane_b32 s53, v51, 32
    v_readlane_b32 s54, v52, 0
    v_readlane_b32 s55, v52, 32
    s_nop 0
L_NORM:
    v_lshlrev_b32 v16, 16, v160
    v_lshlrev_b32 v17, 16, v164
    v_pk_add_f32 v[16:17], v[16:17], s[50:51] neg_lo:[0,1] neg_hi:[0,1]
    v_cvt_pk_bf16_f32 v48, v16, v17
    v_lshlrev_b32 v16, 16, v48
    v_and_b32 v17, s45, v48
    v_pk_mul_f32 v[50:51], v[16:17], s[54:55]
    v_pk_fma_f32 v[52:53], v[50:51], s[52:53], v[16:17] neg_lo:[1,0,0] neg_hi:[1,0,0]
    v_pk_fma_f32 v[50:51], v[52:53], s[54:55], v[50:51]
    v_cvt_pk_bf16_f32 v48, v50, v51
    v_lshlrev_b32 v16, 16, v48
    v_and_b32 v17, s45, v48
    v_and_b32 v18, s45, v160
    v_and_b32 v19, s45, v164
    v_pk_add_f32 v[18:19], v[18:19], s[50:51] neg_lo:[0,1] neg_hi:[0,1]
    v_cvt_pk_bf16_f32 v48, v18, v19
    v_lshlrev_b32 v18, 16, v48
    v_and_b32 v19, s45, v48
    v_pk_mul_f32 v[50:51], v[18:19], s[54:55]
    v_pk_fma_f32 v[52:53], v[50:51], s[52:53], v[18:19] neg_lo:[1,0,0] neg_hi:[1,0,0]
    v_pk_fma_f32 v[50:51], v[52:53], s[54:55], v[50:51]
    v_cvt_pk_bf16_f32 v48, v50, v51
    v_lshlrev_b32 v18, 16, v48
    v_and_b32 v19, s45, v48
    v_lshlrev_b32 v20, 16, v161
    v_lshlrev_b32 v21, 16, v165
    v_pk_add_f32 v[20:21], v[20:21], s[50:51] neg_lo:[0,1] neg_hi:[0,1]
    v_cvt_pk_bf16_f32 v48, v20, v21
    v_lshlrev_b32 v20, 16, v48
    v_and_b32 v21, s45, v48
    v_pk_mul_f32 v[50:51], v[20:21], s[54:55]
    v_pk_fma_f32 v[52:53], v[50:51], s[52:53], v[20:21] neg_lo:[1,0,0] neg_hi:[1,0,0]
    v_pk_fma_f32 v[50:51], v[52:53], s[54:55], v[50:51]
    v_cvt_pk_bf16_f32 v48, v50, v51
    v_lshlrev_b32 v20, 16, v48
    v_and_b32 v21, s45, v48
    v_and_b32 v22, s45, v161
    v_and_b32 v23, s45, v165
    v_pk_add_f32 v[22:23], v[22:23], s[50:51] neg_lo:[0,1] neg_hi:[0,1]
    v_cvt_pk_bf16_f32 v48, v22, v23
    v_lshlrev_b32 v22, 16, v48
    v_and_b32 v23, s45, v48
    v_pk_mul_f32 v[50:51], v[22:23], s[54:55]
    v_pk_fma_f32 v[52:53], v[50:51], s[52:53], v[22:23] neg_lo:[1,0,0] neg_hi:[1,0,0]
    v_pk_fma_f32 v[50:51], v[52:53], s[54:55], v[50:51]
    v_cvt_pk_bf16_f32 v48, v50, v51
    v_lshlrev_b32 v22, 16, v48
    v_and_b32 v23, s45, v48
    v_lshlrev_b32 v24, 16, v162
    v_lshlrev_b32 v25, 16, v166
    v_pk_add_f32 v[24:25], v[24:25], s[50:51] neg_lo:[0,1] neg_hi:[0,1]
    v_cvt_pk_bf16_f32 v48, v24, v25
    v_lshlrev_b32 v24, 16, v48
    v_and_b32 v25, s45, v48
    v_pk_mul_f32 v[50:51], v[24:25], s[54:55]
    v_pk_fma_f32 v[52:53], v[50:51], s[52:53], v[24:25] neg_lo:[1,0,0] neg_hi:[1,0,0]
    v_pk_fma_f32 v[50:51], v[52:53], s[54:55], v[50:51]
    v_cvt_pk_bf16_f32 v48, v50, v51
    v_lshlrev_b32 v24, 16, v48
    v_and_b32 v25, s45, v48
    v_and_b32 v26, s45, v162
    v_and_b32 v27, s45, v166
    v_pk_add_f32 v[26:27], v[26:27], s[50:51] neg_lo:[0,1] neg_hi:[0,1]
    v_cvt_pk_bf16_f32 v48, v26, v27
    v_lshlrev_b32 v26, 16, v48
    v_and_b32 v27, s45, v48
    v_pk_mul_f32 v[50:51], v[26:27], s[54:55]
    v_pk_fma_f32 v[52:53], v[50:51], s[52:53], v[26:27] neg_lo:[1,0,0] neg_hi:[1,0,0]
    v_pk_fma_f32 v[50:51], v[52:53], s[54:55], v[50:51]
    v_cvt_pk_bf16_f32 v48, v50, v51
    v_lshlrev_b32 v26, 16, v48
    v_and_b32 v27, s45, v48
    v_lshlrev_b32 v28, 16, v163
    v_lshlrev_b32 v29, 16, v167
    v_pk_add_f32 v[28:29], v[28:29], s[50:51] neg_lo:[0,1] neg_hi:[0,1]
    v_cvt_pk_bf16_f32 v48, v28, v29
    v_lshlrev_b32 v28, 16, v48
    v_and_b32 v29, s45, v48
    v_pk_mul_f32 v[50:51], v[28:29], s[54:55]
    v_pk_fma_f32 v[52:53], v[50:51], s[52:53], v[28:29] neg_lo:[1,0,0] neg_hi:[1,0,0]
    v_pk_fma_f32 v[50:51], v[52:53], s[54:55], v[50:51]
    v_cvt_pk_bf16_f32 v48, v50, v51
    v_lshlrev_b32 v28, 16, v48
    v_and_b32 v29, s45, v48
    v_and_b32 v30, s45, v163
    v_and_b32 v31, s45, v167
    v_pk_add_f32 v[30:31], v[30:31], s[50:51] neg_lo:[0,1] neg_hi:[0,1]
    v_cvt_pk_bf16_f32 v48, v30, v31
    v_lshlrev_b32 v30, 16, v48
    v_and_b32 v31, s45, v48
    v_pk_mul_f32 v[50:51], v[30:31], s[54:55]
    v_pk_fma_f32 v[52:53], v[50:51], s[52:53], v[30:31] neg_lo:[1,0,0] neg_hi:[1,0,0]
    v_pk_fma_f32 v[50:51], v[52:53], s[54:55], v[50:51]
    v_cvt_pk_bf16_f32 v48, v50, v51
    v_lshlrev_b32 v30, 16, v48
    v_and_b32 v31, s45, v48
    v_mov_b32 v32, 0
    v_mov_b32 v33, 0
    v_mov_b32 v34, 0
    v_mov_b32 v35, 0
    v_mov_b32 v36, 0
    v_mov_b32 v37, 0
    v_mov_b32 v38, 0
    v_mov_b32 v39, 0
    v_mov_b32 v40, 0
    v_mov_b32 v41, 0
    v_mov_b32 v42, 0
    v_mov_b32 v43, 0
    v_mov_b32 v44, 0
    v_mov_b32 v45, 0
    v_mov_b32 v46, 0
    v_mov_b32 v47, 0
    s_cmp_eq_u32 s48, 1
    s_cbranch_scc1 L_UN1Q
    s_waitcnt vmcnt(3)
L_UN0:
    v_lshlrev_b32 v96, 16, v64
    v_and_b32 v97, s45, v64
    v_lshlrev_b32 v98, 16, v65
    v_and_b32 v99, s45, v65
    v_lshlrev_b32 v100, 16, v66
    v_and_b32 v101, s45, v66
    v_lshlrev_b32 v102, 16, v67
    v_and_b32 v103, s45, v67
    v_lshlrev_b32 v104, 16, v68
    v_and_b32 v105, s45, v68
    v_lshlrev_b32 v106, 16, v69
    v_and_b32 v107, s45, v69
    v_lshlrev_b32 v108, 16, v70
    v_and_b32 v109, s45, v70
    v_lshlrev_b32 v110, 16, v71
    v_and_b32 v111, s45, v71
    v_lshlrev_b32 v112, 16, v72
    v_and_b32 v113, s45, v72
    v_lshlrev_b32 v114, 16, v73
    v_and_b32 v115, s45, v73
    v_lshlrev_b32 v116, 16, v74
    v_and_b32 v117, s45, v74
    v_lshlrev_b32 v118, 16, v75
    v_and_b32 v119, s45, v75
    v_lshlrev_b32 v120, 16, v76
    v_and_b32 v121, s45, v76
    v_lshlrev_b32 v122, 16, v77
    v_and_b32 v123, s45, v77
    v_lshlrev_b32 v124, 16, v78
    v_and_b32 v125, s45, v78
    v_lshlrev_b32 v126, 16, v79
    v_and_b32 v127, s45, v79
    v_lshlrev_b32 v128, 16, v80
    v_and_b32 v129, s45, v80
    v_lshlrev_b32 v130, 16, v81
    v_and_b32 v131, s45, v81
    v_lshlrev_b32 v132, 16, v82
    v_and_b32 v133, s45, v82
    v_lshlrev_b32 v134, 16, v83
    v_and_b32 v135, s45, v83
    v_lshlrev_b32 v136, 16, v84
    v_and_b32 v137, s45, v84
    v_lshlrev_b32 v138, 16, v85
    v_and_b32 v139, s45, v85
    v_lshlrev_b32 v140, 16, v86
    v_and_b32 v141, s45, v86
    v_lshlrev_b32 v142, 16, v87
    v_and_b32 v143, s45, v87
    v_lshlrev_b32 v144, 16, v88
    v_and_b32 v145, s45, v88
    v_lshlrev_b32 v146, 16, v89
    v_and_b32 v147, s45, v89
    v_lshlrev_b32 v148, 16, v90
    v_and_b32 v149, s45, v90
    v_lshlrev_b32 v150, 16, v91
    v_and_b32 v151, s45, v91
    v_lshlrev_b32 v152, 16, v92
    v_and_b32 v153, s45, v92
    v_lshlrev_b32 v154, 16, v93
    v_and_b32 v155, s45, v93
    v_lshlrev_b32 v156, 16, v94
    v_and_b32 v157, s45, v94
    v_lshlrev_b32 v158, 16, v95
    v_and_b32 v159, s45, v95
    s_branch L_FMA
L_UN1Q:
    s_waitcnt vmcnt(0)
    global_load_dwordx4 v[176:179], v10, s[28:29] sc1
    global_load_dwordx4 v[180:183], v12, s[28:29] sc1
    global_load_dwordx4 v[184:187], v56, s[28:29] sc1
    global_load_dwordx4 v[188:191], v59, s[28:29] sc1
L_UN1:
    v_lshlrev_b32 v96, 16, v192
    v_and_b32 v97, s45, v192
    v_lshlrev_b32 v98, 16, v193
    v_and_b32 v99, s45, v193
    v_lshlrev_b32 v100, 16, v194
    v_and_b32 v101, s45, v194
    v_lshlrev_b32 v102, 16, v195
    v_and_b32 v103, s45, v195
    v_lshlrev_b32 v104, 16, v196
    v_and_b32 v105, s45, v196
    v_lshlrev_b32 v106, 16, v197
    v_and_b32 v107, s45, v197
    v_lshlrev_b32 v108, 16, v198
    v_and_b32 v109, s45, v198
    v_lshlrev_b32 v110, 16, v199
    v_and_b32 v111, s45, v199
    v_lshlrev_b32 v112, 16, v200
    v_and_b32 v113, s45, v200
    v_lshlrev_b32 v114, 16, v201
    v_and_b32 v115, s45, v201
    v_lshlrev_b32 v116, 16, v202
    v_and_b32 v117, s45, v202
    v_lshlrev_b32 v118, 16, v203
    v_and_b32 v119, s45, v203
    v_lshlrev_b32 v120, 16, v204
    v_and_b32 v121, s45, v204
    v_lshlrev_b32 v122, 16, v205
    v_and_b32 v123, s45, v205
    v_lshlrev_b32 v124, 16, v206
    v_and_b32 v125, s45, v206
    v_lshlrev_b32 v126, 16, v207
    v_and_b32 v127, s45, v207
    v_lshlrev_b32 v128, 16, v208
    v_and_b32 v129, s45, v208
    v_lshlrev_b32 v130, 16, v209
    v_and_b32 v131, s45, v209
    v_lshlrev_b32 v132, 16, v210
    v_and_b32 v133, s45, v210
    v_lshlrev_b32 v134, 16, v211
    v_and_b32 v135, s45, v211
    v_lshlrev_b32 v136, 16, v212
    v_and_b32 v137, s45, v212
    v_lshlrev_b32 v138, 16, v213
    v_and_b32 v139, s45, v213
    v_lshlrev_b32 v140, 16, v214
    v_and_b32 v141, s45, v214
    v_lshlrev_b32 v142, 16, v215
    v_and_b32 v143, s45, v215
    v_lshlrev_b32 v144, 16, v216
    v_and_b32 v145, s45, v216
    v_lshlrev_b32 v146, 16, v217
    v_and_b32 v147, s45, v217
    v_lshlrev_b32 v148, 16, v218
    v_and_b32 v149, s45, v218
    v_lshlrev_b32 v150, 16, v219
    v_and_b32 v151, s45, v219
    v_lshlrev_b32 v152, 16, v220
    v_and_b32 v153, s45, v220
    v_lshlrev_b32 v154, 16, v221
    v_and_b32 v155, s45, v221
    v_lshlrev_b32 v156, 16, v222
    v_and_b32 v157, s45, v222
    v_lshlrev_b32 v158, 16, v223
    v_and_b32 v159, s45, v223
    s_cmp_eq_u32 s48, 3
    s_cbranch_scc1 L_H1
L_FMA:
    v_pk_fma_f32 v[32:33], v[96:97], v[16:17], v[32:33] op_sel:[0,0,0] op_sel_hi:[0,1,1]
    v_pk_fma_f32 v[34:35], v[96:97], v[16:17], v[34:35] op_sel:[1,0,0] op_sel_hi:[1,1,1]
    v_pk_fma_f32 v[36:37], v[98:99], v[16:17], v[36:37] op_sel:[0,0,0] op_sel_hi:[0,1,1]
    v_pk_fma_f32 v[38:39], v[98:99], v[16:17], v[38:39] op_sel:[1,0,0] op_sel_hi:[1,1,1]
    v_pk_fma_f32 v[40:41], v[100:101], v[16:17], v[40:41] op_sel:[0,0,0] op_sel_hi:[0,1,1]
    v_pk_fma_f32 v[42:43], v[100:101], v[16:17], v[42:43] op_sel:[1,0,0] op_sel_hi:[1,1,1]
    v_pk_fma_f32 v[44:45], v[102:103], v[16:17], v[44:45] op_sel:[0,0,0] op_sel_hi:[0,1,1]
    v_pk_fma_f32 v[46:47], v[102:103], v[16:17], v[46:47] op_sel:[1,0,0] op_sel_hi:[1,1,1]
    v_pk_fma_f32 v[32:33], v[104:105], v[18:19], v[32:33] op_sel:[0,0,0] op_sel_hi:[0,1,1]
    v_pk_fma_f32 v[34:35], v[104:105], v[18:19], v[34:35] op_sel:[1,0,0] op_sel_hi:[1,1,1]
    v_pk_fma_f32 v[36:37], v[106:107], v[18:19], v[36:37] op_sel:[0,0,0] op_sel_hi:[0,1,1]
    v_pk_fma_f32 v[38:39], v[106:107], v[18:19], v[38:39] op_sel:[1,0,0] op_sel_hi:[1,1,1]
    v_pk_fma_f32 v[40:41], v[108:109], v[18:19], v[40:41] op_sel:[0,0,0] op_sel_hi:[0,1,1]
    v_pk_fma_f32 v[42:43], v[108:109], v[18:19], v[42:43] op_sel:[1,0,0] op_sel_hi:[1,1,1]
    v_pk_fma_f32 v[44:45], v[110:111], v[18:19], v[44:45] op_sel:[0,0,0] op_sel_hi:[0,1,1]
    v_pk_fma_f32 v[46:47], v[110:111], v[18:19], v[46:47] op_sel:[1,0,0] op_sel_hi:[1,1,1]
    v_pk_fma_f32 v[32:33], v[112:113], v[20:21], v[32:33] op_sel:[0,0,0] op_sel_hi:[0,1,1]
    v_pk_fma_f32 v[34:35], v[112:113], v[20:21], v[34:35] op_sel:[1,0,0] op_sel_hi:[1,1,1]
    v_pk_fma_f32 v[36:37], v[114:115], v[20:21], v[36:37] op_sel:[0,0,0] op_sel_hi:[0,1,1]
    v_pk_fma_f32 v[38:39], v[114:115], v[20:21], v[38:39] op_sel:[1,0,0] op_sel_hi:[1,1,1]
    v_pk_fma_f32 v[40:41], v[116:117], v[20:21], v[40:41] op_sel:[0,0,0] op_sel_hi:[0,1,1]
    v_pk_fma_f32 v[42:43], v[116:117], v[20:21], v[42:43] op_sel:[1,0,0] op_sel_hi:[1,1,1]
    v_pk_fma_f32 v[44:45], v[118:119], v[20:21], v[44:45] op_sel:[0,0,0] op_sel_hi:[0,1,1]
    v_pk_fma_f32 v[46:47], v[118:119], v[20:21], v[46:47] op_sel:[1,0,0] op_sel_hi:[1,1,1]
    v_pk_fma_f32 v[32:33], v[120:121], v[22:23], v[32:33] op_sel:[0,0,0] op_sel_hi:[0,1,1]
    v_pk_fma_f32 v[34:35], v[120:121], v[22:23], v[34:35] op_sel:[1,0,0] op_sel_hi:[1,1,1]
    v_pk_fma_f32 v[36:37], v[122:123], v[22:23], v[36:37] op_sel:[0,0,0] op_sel_hi:[0,1,1]
    v_pk_fma_f32 v[38:39], v[122:123], v[22:23], v[38:39] op_sel:[1,0,0] op_sel_hi:[1,1,1]
    v_pk_fma_f32 v[40:41], v[124:125], v[22:23], v[40:41] op_sel:[0,0,0] op_sel_hi:[0,1,1]
    v_pk_fma_f32 v[42:43], v[124:125], v[22:23], v[42:43] op_sel:[1,0,0] op_sel_hi:[1,1,1]
    v_pk_fma_f32 v[44:45], v[126:127], v[22:23], v[44:45] op_sel:[0,0,0] op_sel_hi:[0,1,1]
    v_pk_fma_f32 v[46:47], v[126:127], v[22:23], v[46:47] op_sel:[1,0,0] op_sel_hi:[1,1,1]
    v_pk_fma_f32 v[32:33], v[128:129], v[24:25], v[32:33] op_sel:[0,0,0] op_sel_hi:[0,1,1]
    v_pk_fma_f32 v[34:35], v[128:129], v[24:25], v[34:35] op_sel:[1,0,0] op_sel_hi:[1,1,1]
    v_pk_fma_f32 v[36:37], v[130:131], v[24:25], v[36:37] op_sel:[0,0,0] op_sel_hi:[0,1,1]
    v_pk_fma_f32 v[38:39], v[130:131], v[24:25], v[38:39] op_sel:[1,0,0] op_sel_hi:[1,1,1]
    v_pk_fma_f32 v[40:41], v[132:133], v[24:25], v[40:41] op_sel:[0,0,0] op_sel_hi:[0,1,1]
    v_pk_fma_f32 v[42:43], v[132:133], v[24:25], v[42:43] op_sel:[1,0,0] op_sel_hi:[1,1,1]
    v_pk_fma_f32 v[44:45], v[134:135], v[24:25], v[44:45] op_sel:[0,0,0] op_sel_hi:[0,1,1]
    v_pk_fma_f32 v[46:47], v[134:135], v[24:25], v[46:47] op_sel:[1,0,0] op_sel_hi:[1,1,1]
    v_pk_fma_f32 v[32:33], v[136:137], v[26:27], v[32:33] op_sel:[0,0,0] op_sel_hi:[0,1,1]
    v_pk_fma_f32 v[34:35], v[136:137], v[26:27], v[34:35] op_sel:[1,0,0] op_sel_hi:[1,1,1]
    v_pk_fma_f32 v[36:37], v[138:139], v[26:27], v[36:37] op_sel:[0,0,0] op_sel_hi:[0,1,1]
    v_pk_fma_f32 v[38:39], v[138:139], v[26:27], v[38:39] op_sel:[1,0,0] op_sel_hi:[1,1,1]
    v_pk_fma_f32 v[40:41], v[140:141], v[26:27], v[40:41] op_sel:[0,0,0] op_sel_hi:[0,1,1]
    v_pk_fma_f32 v[42:43], v[140:141], v[26:27], v[42:43] op_sel:[1,0,0] op_sel_hi:[1,1,1]
    v_pk_fma_f32 v[44:45], v[142:143], v[26:27], v[44:45] op_sel:[0,0,0] op_sel_hi:[0,1,1]
    v_pk_fma_f32 v[46:47], v[142:143], v[26:27], v[46:47] op_sel:[1,0,0] op_sel_hi:[1,1,1]
    v_pk_fma_f32 v[32:33], v[144:145], v[28:29], v[32:33] op_sel:[0,0,0] op_sel_hi:[0,1,1]
    v_pk_fma_f32 v[34:35], v[144:145], v[28:29], v[34:35] op_sel:[1,0,0] op_sel_hi:[1,1,1]
    v_pk_fma_f32 v[36:37], v[146:147], v[28:29], v[36:37] op_sel:[0,0,0] op_sel_hi:[0,1,1]
    v_pk_fma_f32 v[38:39], v[146:147], v[28:29], v[38:39] op_sel:[1,0,0] op_sel_hi:[1,1,1]
    v_pk_fma_f32 v[40:41], v[148:149], v[28:29], v[40:41] op_sel:[0,0,0] op_sel_hi:[0,1,1]
    v_pk_fma_f32 v[42:43], v[148:149], v[28:29], v[42:43] op_sel:[1,0,0] op_sel_hi:[1,1,1]
    v_pk_fma_f32 v[44:45], v[150:151], v[28:29], v[44:45] op_sel:[0,0,0] op_sel_hi:[0,1,1]
    v_pk_fma_f32 v[46:47], v[150:151], v[28:29], v[46:47] op_sel:[1,0,0] op_sel_hi:[1,1,1]
    v_pk_fma_f32 v[32:33], v[152:153], v[30:31], v[32:33] op_sel:[0,0,0] op_sel_hi:[0,1,1]
    v_pk_fma_f32 v[34:35], v[152:153], v[30:31], v[34:35] op_sel:[1,0,0] op_sel_hi:[1,1,1]
    v_pk_fma_f32 v[36:37], v[154:155], v[30:31], v[36:37] op_sel:[0,0,0] op_sel_hi:[0,1,1]
    v_pk_fma_f32 v[38:39], v[154:155], v[30:31], v[38:39] op_sel:[1,0,0] op_sel_hi:[1,1,1]
    v_pk_fma_f32 v[40:41], v[156:157], v[30:31], v[40:41] op_sel:[0,0,0] op_sel_hi:[0,1,1]
    v_pk_fma_f32 v[42:43], v[156:157], v[30:31], v[42:43] op_sel:[1,0,0] op_sel_hi:[1,1,1]
    v_pk_fma_f32 v[44:45], v[158:159], v[30:31], v[44:45] op_sel:[0,0,0] op_sel_hi:[0,1,1]
    v_pk_fma_f32 v[46:47], v[158:159], v[30:31], v[46:47] op_sel:[1,0,0] op_sel_hi:[1,1,1]
    s_cmp_eq_u32 s48, 2
    s_cbranch_scc1 L_P3
    v_permlane32_swap_b32 v32, v33
    v_permlane32_swap_b32 v34, v35
    v_permlane32_swap_b32 v36, v37
    v_permlane32_swap_b32 v38, v39
    v_permlane32_swap_b32 v40, v41
    v_permlane32_swap_b32 v42, v43
    v_permlane32_swap_b32 v44, v45
    v_permlane32_swap_b32 v46, v47
    v_add_f32 v48, v32, v33
    v_add_f32 v49, v34, v35
    v_add_f32 v50, v36, v37
    v_add_f32 v51, v38, v39
    v_add_f32 v52, v40, v41
    v_add_f32 v53, v42, v43
    v_add_f32 v54, v44, v45
    v_add_f32 v55, v46, v47
    v_permlane16_swap_b32 v48, v52
    v_permlane16_swap_b32 v49, v53
    v_permlane16_swap_b32 v50, v54
    v_permlane16_swap_b32 v51, v55
    v_add_f32 v48, v48, v52
    v_add_f32 v49, v49, v53
    v_add_f32 v50, v50, v54
    v_add_f32 v51, v51, v55
    s_cmp_eq_u32 s48, 3
    s_cbranch_scc1 L_PUB2
    v_add_f32_dpp v48, v48, v48 row_ror:8 row_mask:0xf bank_mask:0xf
    v_add_f32_dpp v49, v49, v49 row_ror:8 row_mask:0xf bank_mask:0xf
    v_add_f32_dpp v50, v50, v50 row_ror:8 row_mask:0xf bank_mask:0xf
    v_add_f32_dpp v51, v51, v51 row_ror:8 row_mask:0xf bank_mask:0xf
    s_cmp_eq_u32 s48, 1
    s_cbranch_scc1 L_POST1
    v_mov_b32 v57, 1
    s_waitcnt vmcnt(0)
    ds_write_b128 v13, v[48:51] offset:18432
    s_mov_b64 exec, 1
    ds_add_rtn_u32 v60, v63, v57
    s_mov_b64 exec, -1
    s_mov_b32 s48, 1
    v_and_b32 v57, 31, v0
    v_lshlrev_b32 v57, 4, v57
    s_lshl_b32 s38, s33, 15
    s_lshl_b32 s39, s32, 8
    s_add_u32 s38, s38, s39
    v_and_b32 v58, 1, v1
    v_lshlrev_b32 v58, 14, v58
    v_lshl_add_u32 v58, v2, 4, v58
    v_add_u32 v58, s38, v58
    s_waitcnt lgkmcnt(0)
    v_readfirstlane_b32 s38, v60
    s_cmp_lg_u32 s38, 3
    s_cbranch_scc1 L_QP_DONE
    ds_read_b128 v[32:35], v57 offset:18432
    ds_read_b128 v[36:39], v57 offset:18944
    ds_read_b128 v[40:43], v57 offset:19456
    ds_read_b128 v[44:47], v57 offset:19968
    s_waitcnt lgkmcnt(0)
    v_pk_add_f32 v[32:33], v[32:33], v[36:37]
    v_pk_add_f32 v[34:35], v[34:35], v[38:39]
    v_pk_add_f32 v[40:41], v[40:41], v[44:45]
    v_pk_add_f32 v[42:43], v[42:43], v[46:47]
    v_pk_add_f32 v[32:33], v[32:33], v[40:41]
    v_pk_add_f32 v[34:35], v[34:35], v[42:43]
    v_and_or_b32 v32, v32, s57, v61
    v_and_or_b32 v33, v33, s57, v61
    v_and_or_b32 v34, v34, s57, v61
    v_and_or_b32 v35, v35, s57, v61
    s_mov_b32 exec_hi, 0
    global_store_dwordx4 v58, v[32:35], s[28:29] sc1
    s_mov_b32 exec_hi, -1
L_QP_DONE:
    s_mov_b32 s49, 40000
    s_cmp_ge_u32 s2, 224
    s_cbranch_scc1 L_REQ
    global_load_dwordx4 v[192:195], v11, s[16:17] nt
    v_add_u32 v11, s42, v11
    global_load_dwordx4 v[196:199], v11, s[16:17] nt
    v_add_u32 v11, s42, v11
    global_load_dwordx4 v[200:203], v11, s[16:17] nt
    v_add_u32 v11, s42, v11
    global_load_dwordx4 v[204:207], v11, s[16:17] nt
    v_add_u32 v11, s42, v11
    global_load_dwordx4 v[208:211], v11, s[16:17] nt
    v_add_u32 v11, s42, v11
    global_load_dwordx4 v[212:215], v11, s[16:17] nt
    v_add_u32 v11, s42, v11
    global_load_dwordx4 v[216:219], v11, s[16:17] nt
    v_add_u32 v11, s42, v11
    global_load_dwordx4 v[220:223], v11, s[16:17] nt
    v_mov_b32 v160, v168
    v_mov_b32 v161, v169
    v_mov_b32 v162, v170
    v_mov_b32 v163, v171
    v_mov_b32 v164, v172
    v_mov_b32 v165, v173
    v_mov_b32 v166, v174
    v_mov_b32 v167, v175
    s_branch L_NORM
L_POST1:
    v_and_or_b32 v48, v48, s57, v61
    v_and_or_b32 v49, v49, s57, v61
    v_and_or_b32 v50, v50, s57, v61
    v_and_or_b32 v51, v51, s57, v61
    s_mov_b32 exec_lo, 0x00ff00ff
    s_mov_b32 exec_hi, 0x00ff00ff
    global_store_dwordx4 v15, v[48:51], s[28:29] sc1
    s_mov_b64 exec, -1
    s_waitcnt vmcnt(1)
L_POLLQ:
    v_xor_b32 v176, s56, v176
    v_xor_b32 v177, s56, v177
    v_xor_b32 v178, s56, v178
    v_xor_b32 v179, s56, v179
    v_xor_b32 v180, s56, v180
    v_xor_b32 v181, s56, v181
    v_xor_b32 v182, s56, v182
    v_xor_b32 v183, s56, v183
    v_xor_b32 v184, s56, v184
    v_xor_b32 v185, s56, v185
    v_xor_b32 v186, s56, v186
    v_xor_b32 v187, s56, v187
    v_xor_b32 v188, s56, v188
    v_xor_b32 v189, s56, v189
    v_xor_b32 v190, s56, v190
    v_xor_b32 v191, s56, v191
    v_or3_b32 v60, v176, v177, v178
    v_or3_b32 v60, v60, v179, v180
    v_or3_b32 v60, v60, v181, v182
    v_or3_b32 v60, v60, v183, v184
    v_or3_b32 v60, v60, v185, v186
    v_or3_b32 v60, v60, v187, v188
    v_or3_b32 v60, v60, v189, v190
    v_or_b32 v60, v60, v191
    v_and_b32 v60, 0xff, v60
    v_cmp_ne_u32 vcc, 0, v60
    s_cbranch_vccz L_POLLQ_OK
    s_sub_u32 s49, s49, 1
    s_cbranch_scc1 L_POLLQ_OK
    s_mov_b64 exec, vcc
L_REQ:
    s_sleep 4
    global_load_dwordx4 v[176:179], v10, s[28:29] sc1
    global_load_dwordx4 v[180:183], v12, s[28:29] sc1
    global_load_dwordx4 v[184:187], v56, s[28:29] sc1
    global_load_dwordx4 v[188:191], v59, s[28:29] sc1
    s_waitcnt vmcnt(0)
    s_branch L_POLLQ
L_POLLQ_OK:
    s_mov_b64 exec, -1
    v_pk_add_f32 v[176:177], v[176:177], v[180:181]
    v_pk_add_f32 v[184:185], v[184:185], v[188:189]
    v_pk_add_f32 v[176:177], v[176:177], v[184:185]
    v_cvt_pk_bf16_f32 v32, v176, v177
    v_pk_add_f32 v[178:179], v[178:179], v[182:183]
    v_pk_add_f32 v[186:187], v[186:187], v[190:191]
    v_pk_add_f32 v[178:179], v[178:179], v[186:187]
    v_cvt_pk_bf16_f32 v33, v178, v179
    s_lshl_b32 s38, s3, 9
    v_lshl_add_u32 v58, v0, 3, s38
    ds_write_b64 v58, v[32:33] offset:16384
    s_waitcnt lgkmcnt(0)
    s_barrier
    s_setprio 0
L_PASS2:
    s_mov_b32 s48, 2
    v_lshlrev_b32 v10, 6, v1
    s_lshl_b32 s38, s43, 16
    v_add_u32 v11, s38, v9
    s_lshr_b32 s38, s2, 1
    s_lshl_b32 s38, s38, 16
    v_add_u32 v12, s38, v9
    v_mov_b32 v32, 0
    v_mov_b32 v33, 0
    v_mov_b32 v34, 0
    v_mov_b32 v35, 0
    v_mov_b32 v36, 0
    v_mov_b32 v37, 0
    v_mov_b32 v38, 0
    v_mov_b32 v39, 0
    v_mov_b32 v40, 0
    v_mov_b32 v41, 0
    v_mov_b32 v42, 0
    v_mov_b32 v43, 0
    v_mov_b32 v44, 0
    v_mov_b32 v45, 0
    v_mov_b32 v46, 0
    v_mov_b32 v47, 0
    s_cmp_lg_u32 s3, 1
    s_cbranch_scc1 L_NOPRE
    s_cmp_ge_u32 s2, 128
    s_cbranch_scc1 L_NOPRE
    s_lshl_b32 s39, s2, 13
    s_add_u32 s38, s39, 3149824
    v_lshl_add_u32 v57, v0, 4, s38
    global_load_dwordx4 v[96:99], v57, s[28:29] offset:-4096
    global_load_dwordx4 v[100:103], v57, s[28:29] offset:-3072
    global_load_dwordx4 v[104:107], v57, s[28:29] offset:-2048
    global_load_dwordx4 v[108:111], v57, s[28:29] offset:-1024
    global_load_dwordx4 v[112:115], v57, s[28:29] offset:0
    global_load_dwordx4 v[116:119], v57, s[28:29] offset:1024
    global_load_dwordx4 v[120:123], v57, s[28:29] offset:2048
    global_load_dwordx4 v[124:127], v57, s[28:29] offset:3072
L_NOPRE:
    s_cmp_lg_u32 s3, 0
    s_cbranch_scc1 L_WAITF
    s_cmp_ge_u32 s2, 224
    s_cbranch_scc1 L_TRIG
    s_lshl_b32 s38, s43, 12
    s_add_u32 s38, s38, 524288
    v_lshl_add_u32 v57, v0, 4, s38
    s_mov_b32 s49, 40000
L_POLLH:
    s_sleep 8
    global_load_dwordx4 v[176:179], v57, s[28:29] offset:0 sc1
    global_load_dwordx4 v[180:183], v57, s[28:29] offset:1024 sc1
    global_load_dwordx4 v[184:187], v57, s[28:29] offset:2048 sc1
    global_load_dwordx4 v[188:191], v57, s[28:29] offset:3072 sc1
    s_waitcnt vmcnt(0)
    v_xor_b32 v176, s56, v176
    v_xor_b32 v177, s56, v177
    v_xor_b32 v178, s56, v178
    v_xor_b32 v179, s56, v179
    v_xor_b32 v180, s56, v180
    v_xor_b32 v181, s56, v181
    v_xor_b32 v182, s56, v182
    v_xor_b32 v183, s56, v183
    v_xor_b32 v184, s56, v184
    v_xor_b32 v185, s56, v185
    v_xor_b32 v186, s56, v186
    v_xor_b32 v187, s56, v187
    v_xor_b32 v188, s56, v188
    v_xor_b32 v189, s56, v189
    v_xor_b32 v190, s56, v190
    v_xor_b32 v191, s56, v191
    v_or3_b32 v60, v176, v177, v178
    v_or3_b32 v60, v60, v179, v180
    v_or3_b32 v60, v60, v181, v182
    v_or3_b32 v60, v60, v183, v184
    v_or3_b32 v60, v60, v185, v186
    v_or3_b32 v60, v60, v187, v188
    v_or3_b32 v60, v60, v189, v190
    v_or_b32 v60, v60, v191
    v_and_b32 v60, 0xff, v60
    v_cmp_ne_u32 vcc, 0, v60
    s_cbranch_vccz L_POLLH_OK
    s_mov_b64 exec, vcc
    s_sub_u32 s49, s49, 1
    s_cbranch_scc0 L_POLLH
L_POLLH_OK:
    s_mov_b64 exec, -1
    v_pk_add_f32 v[176:177], v[176:177], v[180:181]
    v_pk_add_f32 v[178:179], v[178:179], v[182:183]
    v_pk_add_f32 v[184:185], v[184:185], v[188:189]
    v_pk_add_f32 v[186:187], v[186:187], v[190:191]
    v_pk_add_f32 v[176:177], v[176:177], v[184:185]
    v_pk_add_f32 v[178:179], v[178:179], v[186:187]
    s_nop 1
    v_permlane32_swap_b32 v176, v178
    v_permlane32_swap_b32 v177, v179
    v_add_f32 v176, v176, v178
    v_add_f32 v177, v177, v179
    s_nop 1
    v_permlane16_swap_b32 v176, v177
    v_add_f32 v176, v176, v177
    v_cvt_pk_bf16_f32 v176, v176, v176
    v_and_b32 v176, s45, v176
    v_lshlrev_b32 v5, 16, v5
    v_add_f32 v176, v176, v5
    v_cvt_pk_bf16_f32 v176, v176, v176
    v_and_b32 v176, s45, v176
    v_cmp_gt_f32 vcc, v176, 0
    s_nop 1
    v_cndmask_b32 v176, 0, v176, vcc
    v_mul_f32 v176, v176, v176
    v_cvt_pk_bf16_f32 v176, v176, v176
    v_and_b32 v176, s45, v176
    ds_write_b32 v62, v176 offset:20736
    s_waitcnt lgkmcnt(0)
L_TRIG:
    v_mov_b32 v57, 1
    ds_write_b32 v63, v57 offset:8
L_WAITF:
    s_lshr_b32 s38, s2, 3
    s_lshl_b32 s38, s38, 2
    s_add_u32 s38, s38, s3
    s_lshl_b32 s38, s38, 8
    s_add_u32 s38, s38, 393216
    v_mov_b32 v176, s38
    v_mov_b32 v177, 1
    s_lshl_b32 s38, s3, 8
    v_mov_b32 v178, s38
    v_mov_b32 v179, s38
    s_mov_b32 s40, 24
    s_mov_b64 exec, 1
L_CLM:
    s_sleep 1
    ds_read_b32 v180, v178 offset:21504
    s_waitcnt lgkmcnt(0)
    v_readfirstlane_b32 s38, v180
    s_cmp_lt_u32 s38, s40
    s_cbranch_scc1 L_CLM
    global_atomic_add v181, v176, v177, s[28:29] sc0 sc1
    s_add_u32 s40, s40, 2
    s_waitcnt vmcnt(0)
    v_readfirstlane_b32 s38, v181
    v_min_u32 v181, 16, v181
    v_add_u32 v181, 1, v181
    ds_write_b32 v179, v181 offset:22528
    v_add_u32 v179, 4, v179
    s_cmp_lt_u32 s38, 16
    s_cbranch_scc1 L_CLM
    s_mov_b64 exec, -1
L_WAITF2:
    ds_read_b32 v176, v63 offset:8
    s_waitcnt lgkmcnt(0)
    v_readfirstlane_b32 s38, v176
    s_cmp_eq_u32 s38, 0
    s_cbranch_scc1 L_WAITF2
L_GO:
    s_cmp_ge_u32 s2, 224
    s_cbranch_scc1 L_NOW2
    global_load_dwordx4 v[64:67], v11, s[20:21] offset:-4096 nt
    global_load_dwordx4 v[68:71], v11, s[20:21] offset:-2048 nt
    global_load_dwordx4 v[72:75], v11, s[20:21] offset:0 nt
    global_load_dwordx4 v[76:79], v11, s[20:21] offset:2048 nt
    v_add_u32 v11, 0x2000, v11
    global_load_dwordx4 v[80:83], v11, s[20:21] offset:-4096 nt
    global_load_dwordx4 v[84:87], v11, s[20:21] offset:-2048 nt
    global_load_dwordx4 v[88:91], v11, s[20:21] offset:0 nt
    global_load_dwordx4 v[92:95], v11, s[20:21] offset:2048 nt
L_NOW2:
    global_load_dwordx4 v[192:195], v12, s[12:13] offset:-4096 nt
    global_load_dwordx4 v[196:199], v12, s[12:13] offset:-2048 nt
    global_load_dwordx4 v[200:203], v12, s[12:13] offset:0 nt
    global_load_dwordx4 v[204:207], v12, s[12:13] offset:2048 nt
    v_add_u32 v12, 0x2000, v12
    global_load_dwordx4 v[208:211], v12, s[12:13] offset:-4096 nt
    global_load_dwordx4 v[212:215], v12, s[12:13] offset:-2048 nt
    global_load_dwordx4 v[216:219], v12, s[12:13] offset:0 nt
    global_load_dwordx4 v[220:223], v12, s[12:13] offset:2048 nt
    ds_read_b128 v[16:19], v10 offset:20736
    ds_read_b128 v[20:23], v10 offset:20752
    ds_read_b128 v[24:27], v10 offset:20768
    ds_read_b128 v[28:31], v10 offset:20784
    v_lshlrev_b32 v7, 16, v7
    v_lshlrev_b32 v6, 16, v6
    v_add_f32 v7, v7, v6
    s_lshl_b32 s39, s2, 13
    s_add_u32 s38, s39, 3149824
    v_lshl_add_u32 v57, v0, 4, s38
    s_mov_b32 s49, 40000
    s_cmp_ge_u32 s2, 224
    s_cselect_b32 s38, 1, 0
    s_waitcnt vmcnt(8) lgkmcnt(0)
    s_cbranch_scc0 L_UN0
L_P3:
    s_mov_b32 s48, 3
    s_waitcnt vmcnt(0)
    s_branch L_UN1
L_H1:
    s_barrier
    ds_read_b128 v[16:19], v10 offset:20992
    ds_read_b128 v[20:23], v10 offset:21008
    ds_read_b128 v[24:27], v10 offset:21024
    ds_read_b128 v[28:31], v10 offset:21040
    s_waitcnt lgkmcnt(0)
    s_branch L_FMA
L_PUB2:
    v_and_or_b32 v48, v48, s57, v61
    v_and_or_b32 v49, v49, s57, v61
    v_and_or_b32 v50, v50, s57, v61
    v_and_or_b32 v51, v51, s57, v61
    global_store_dwordx4 v14, v[48:51], s[28:29] sc1
    s_cmp_lg_u32 s3, 0
    s_cbranch_scc1 L_END
    s_cmp_ge_u32 s2, 128
    s_cbranch_scc1 L_END
L_POLL2:
    global_load_dwordx4 v[64:67], v57, s[28:29] offset:-4096 sc1
    global_load_dwordx4 v[68:71], v57, s[28:29] offset:-3072 sc1
    global_load_dwordx4 v[72:75], v57, s[28:29] offset:-2048 sc1
    global_load_dwordx4 v[76:79], v57, s[28:29] offset:-1024 sc1
    global_load_dwordx4 v[80:83], v57, s[28:29] offset:0 sc1
    global_load_dwordx4 v[84:87], v57, s[28:29] offset:1024 sc1
    global_load_dwordx4 v[88:91], v57, s[28:29] offset:2048 sc1
    global_load_dwordx4 v[92:95], v57, s[28:29] offset:3072 sc1
    s_waitcnt vmcnt(4)
    v_xor_b32 v64, s56, v64
    v_xor_b32 v65, s56, v65
    v_xor_b32 v66, s56, v66
    v_xor_b32 v67, s56, v67
    v_xor_b32 v68, s56, v68
    v_xor_b32 v69, s56, v69
    v_xor_b32 v70, s56, v70
    v_xor_b32 v71, s56, v71
    v_xor_b32 v72, s56, v72
    v_xor_b32 v73, s56, v73
    v_xor_b32 v74, s56, v74
    v_xor_b32 v75, s56, v75
    v_xor_b32 v76, s56, v76
    v_xor_b32 v77, s56, v77
    v_xor_b32 v78, s56, v78
    v_xor_b32 v79, s56, v79
    s_waitcnt vmcnt(0)
    v_xor_b32 v80, s56, v80
    v_xor_b32 v81, s56, v81
    v_xor_b32 v82, s56, v82
    v_xor_b32 v83, s56, v83
    v_xor_b32 v84, s56, v84
    v_xor_b32 v85, s56, v85
    v_xor_b32 v86, s56, v86
    v_xor_b32 v87, s56, v87
    v_xor_b32 v88, s56, v88
    v_xor_b32 v89, s56, v89
    v_xor_b32 v90, s56, v90
    v_xor_b32 v91, s56, v91
    v_xor_b32 v92, s56, v92
    v_xor_b32 v93, s56, v93
    v_xor_b32 v94, s56, v94
    v_xor_b32 v95, s56, v95
    v_or3_b32 v60, v64, v65, v66
    v_or3_b32 v60, v60, v67, v68
    v_or3_b32 v60, v60, v69, v70
    v_or3_b32 v60, v60, v71, v72
    v_or3_b32 v60, v60, v73, v74
    v_or3_b32 v60, v60, v75, v76
    v_or3_b32 v60, v60, v77, v78
    v_or3_b32 v60, v60, v79, v80
    v_or3_b32 v60, v60, v81, v82
    v_or3_b32 v60, v60, v83, v84
    v_or3_b32 v60, v60, v85, v86
    v_or3_b32 v60, v60, v87, v88
    v_or3_b32 v60, v60, v89, v90
    v_or3_b32 v60, v60, v91, v92
    v_or3_b32 v60, v60, v93, v94
    v_or_b32 v60, v60, v95
    v_and_b32 v60, 0xff, v60
    v_cmp_ne_u32 vcc, 0, v60
    s_cbranch_vccz L_POLL2_OK
    s_mov_b64 exec, vcc
    s_sub_u32 s49, s49, 1
    s_cbranch_scc0 L_POLL2
L_POLL2_OK:
    s_mov_b64 exec, -1
    v_pk_add_f32 v[64:65], v[64:65], v[80:81]
    v_pk_add_f32 v[66:67], v[66:67], v[82:83]
    v_pk_add_f32 v[68:69], v[68:69], v[84:85]
    v_pk_add_f32 v[70:71], v[70:71], v[86:87]
    v_pk_add_f32 v[72:73], v[72:73], v[88:89]
    v_pk_add_f32 v[74:75], v[74:75], v[90:91]
    v_pk_add_f32 v[76:77], v[76:77], v[92:93]
    v_pk_add_f32 v[78:79], v[78:79], v[94:95]
    v_pk_add_f32 v[64:65], v[64:65], v[72:73]
    v_pk_add_f32 v[66:67], v[66:67], v[74:75]
    v_pk_add_f32 v[68:69], v[68:69], v[76:77]
    v_pk_add_f32 v[70:71], v[70:71], v[78:79]
    v_pk_add_f32 v[64:65], v[64:65], v[68:69]
    v_pk_add_f32 v[66:67], v[66:67], v[70:71]
    s_nop 1
    v_permlane32_swap_b32 v64, v66
    v_permlane32_swap_b32 v65, v67
    v_add_f32 v64, v64, v66
    v_add_f32 v65, v65, v67
    s_nop 1
    v_permlane16_swap_b32 v64, v65
    v_add_f32 v64, v64, v65
    s_nop 1
    v_add_f32_dpp v64, v64, v64 row_ror:8 row_mask:0xf bank_mask:0xf
    s_nop 1
    v_add_f32_dpp v64, v64, v64 row_ror:4 row_mask:0xf bank_mask:0xf
    v_add_f32 v64, v64, v7
    v_cvt_pk_bf16_f32 v64, v64, v64
    s_mov_b32 exec_lo, 0x000f000f
    s_mov_b32 exec_hi, 0x000f000f
    global_store_short v8, v64, s[24:25]
    s_cmp_lg_u32 s2, 0
    s_cbranch_scc1 L_END
    s_mov_b64 exec, 1
    v_mov_b32 v1, 131072
    v_mov_b32 v2, s59
    global_store_dword v1, v2, s[28:29] sc1
L_END:
    s_endpgm

.section .rodata,"a"
.p2align 6
.amdhsa_kernel parallel_sum__gqa_block_cached__dense_activation_squared_relu__decode_kernel
  .amdhsa_next_free_vgpr 224
  .amdhsa_next_free_sgpr 102
  .amdhsa_accum_offset 224
  .amdhsa_group_segment_fixed_size 0
  .amdhsa_kernarg_size 104
  .amdhsa_user_sgpr_count 2
  .amdhsa_user_sgpr_kernarg_segment_ptr 1
  .amdhsa_system_sgpr_workgroup_id_x 1
.end_amdhsa_kernel
```
